```python
import torch

def _softmax(x, axis=-1):
    return torch.softmax(x, dim=axis)
def _gelu(x):
    return torch.nn.functional.gelu(x, approximate="tanh")
def _silu(x):
    return torch.nn.functional.silu(x)
def _sigmoid(x):
    return torch.sigmoid(x)
def _layernorm(x, axis=-1, eps=1e-5):
    m = x.mean(dim=axis, keepdim=True)
    v = x.var(dim=axis, keepdim=True, unbiased=False)
    return (x - m) / torch.sqrt(v + eps)
def _scatter_add(tgt, idx, src, axis=0):
    return tgt.clone().index_add_(axis, idx, src)
def _segment_sum(src, seg, n):
    out = torch.zeros((n,) + src.shape[1:], dtype=src.dtype)
    return out.index_add_(0, seg, src)
def _pad(x, pw):
    flat = tuple(v for pair in reversed(pw) for v in pair)
    return torch.nn.functional.pad(x, flat)

kernel_name = 'parallel_sum__ssm_conv_s4__mixer_token_mlp__prompt'

def setup_inputs():

    _w = (lambda a: (lambda t: t.to(torch.bfloat16) if t.is_floating_point() else t)(torch.as_tensor(a)))
    def _A_setup():
        B, L, D, N = 1, 2048, 640, 192
        A_re = -(lambda _x: torch.exp(torch.as_tensor(_x)))((lambda *s: torch.randn(*s, dtype=torch.bfloat16) * 6.4)(D, N))
        A_im = torch.pi * (lambda *s: torch.randn(*s, dtype=torch.bfloat16) * 0.05)(D, N)
        B_re = (lambda *s: torch.randn(*s, dtype=torch.bfloat16) * 0.1)(D, N)
        B_im = (lambda *s: torch.randn(*s, dtype=torch.bfloat16) * 0.1)(D, N)
        C_re = (lambda *s: torch.randn(*s, dtype=torch.bfloat16) * 0.1)(D, N)
        C_im = (lambda *s: torch.randn(*s, dtype=torch.bfloat16) * 0.1)(D, N)
        log_dt = (lambda *s: torch.randn(*s, dtype=torch.bfloat16) * 0.05)(D) * 0.5 - 4.0
        Dskip = (lambda *s: torch.randn(*s, dtype=torch.bfloat16) * 0.05)(D)
        return {
            "u": _w((lambda *s: torch.randn(*s, dtype=torch.bfloat16) * 0.05)(B, L, D)),
            "A_re": _w(A_re),
            "A_im": _w(A_im),
            "B_re": _w(B_re),
            "B_im": _w(B_im),
            "C_re": _w(C_re),
            "C_im": _w(C_im),
            "log_dt": _w(log_dt),
            "Dskip": _w(Dskip),
        }
    _A_in = _A_setup()

    def _B_setup():
        B, S, D, F = 1, 2048, 640, 1536
        return {
            "x": _w((lambda *s: torch.randn(*s, dtype=torch.bfloat16) * 0.05)(B, S, D)),
            "w1": _w((lambda *s: torch.randn(*s, dtype=torch.bfloat16) * 0.8)(S, F) * (S ** -0.5)),
            "b1": _w((lambda *s: torch.randn(*s, dtype=torch.bfloat16) * 0.2)(F) * 0.02),
            "w2": _w((lambda *s: torch.randn(*s, dtype=torch.bfloat16) * 0.2)(F, S) * (F ** -0.5)),
            "b2": _w((lambda *s: torch.randn(*s, dtype=torch.bfloat16) * 0.2)(S) * 0.02),
        }
    _B_in = _B_setup()

    return {
        "A_u": _A_in["u"],
        "A_A_re": _A_in["A_re"],
        "A_A_im": _A_in["A_im"],
        "A_B_re": _A_in["B_re"],
        "A_B_im": _A_in["B_im"],
        "A_C_re": _A_in["C_re"],
        "A_C_im": _A_in["C_im"],
        "A_log_dt": _A_in["log_dt"],
        "A_Dskip": _A_in["Dskip"],
        "B_x": _B_in["x"],
        "B_w1": _B_in["w1"],
        "B_b1": _B_in["b1"],
        "B_w2": _B_in["w2"],
        "B_b2": _B_in["b2"],
    }

def reference(A_u, A_A_re, A_A_im, A_B_re, A_B_im, A_C_re, A_C_im, A_log_dt, A_Dskip, B_x, B_w1, B_b1, B_w2, B_b2):
    def _A_ref(u, A_re, A_im, B_re, B_im, C_re, C_im, log_dt, Dskip):
        Bsz, L, D = u.shape
        dt = torch.exp(log_dt)[:, None]
        A = A_re + 1j * A_im
        Bc = B_re + 1j * B_im
        Cc = C_re + 1j * C_im
        logdA = dt * A
        dB = dt * Bc
        l = (lambda x, dt: x.to(dt))(torch.arange(L), A_re.dtype)
        P = torch.exp(logdA[:, :, None] * l[None, None, :])
        K = torch.einsum("dn,dnl,dn->dl", Cc, P, dB).real
        L2 = 2 * L
        Kp = _pad(K, ((0, 0), (0, L)))
        up = (lambda x, *d: x.permute(*d))(u, 0, 2, 1)
        up = _pad(up, ((0, 0), (0, 0), (0, L)))
        Kf = (lambda x, axes=(-2,-1): torch.fft.rfft2(x.float(), dim=axes))(Kp[:, None, :], axes=(-2, -1))
        Uf = (lambda x, axes=(-2,-1): torch.fft.rfft2(x.float(), dim=axes))(up[:, :, None, :], axes=(-2, -1))
        Yf = Uf * Kf[None, :, :, :]
        y = (lambda x, s, axes=(-2,-1): torch.fft.irfft2(x, s=s, dim=axes).to(torch.bfloat16))(Yf, (1, L2), axes=(-2, -1))[:, :, 0, :L]
        y = (lambda x, *d: x.permute(*d))(y, 0, 2, 1) + u * Dskip[None, None, :]
        return y

    def _B_ref(x, w1, b1, w2, b2):
        B, S, D = x.shape
        h = _layernorm(x, axis=-1)
        u = torch.einsum("bsd,sf->bdf", h, w1) + b1
        u = _gelu(u)
        y = torch.einsum("bdf,fs->bds", u, w2) + b2
        return (lambda x, *d: x.permute(*d))(y, 0, 2, 1)

    x = A_u
    xn = _layernorm(x, axis=-1)
    return x + _A_ref(xn, A_A_re, A_A_im, A_B_re, A_B_im, A_C_re, A_C_im, A_log_dt, A_Dskip) + _B_ref(xn, B_w1, B_b1, B_w2, B_b2)
```

```asm
; @launch grid=(256,1,1) block=(512,1,1) lds=163840
.amdgcn_target "amdgcn-amd-amdhsa--gfx950"
.text
.globl parallel_sum__ssm_conv_s4__mixer_token_mlp__prompt_kernel
.p2align 8
.type parallel_sum__ssm_conv_s4__mixer_token_mlp__prompt_kernel,@function
parallel_sum__ssm_conv_s4__mixer_token_mlp__prompt_kernel:
    s_cmp_ge_u32 s2, 256
    s_cbranch_scc1 L_end0
    s_load_dwordx16 s[16:31], s[0:1], 0
    s_load_dwordx16 s[32:47], s[0:1], 64
    s_load_dwordx2 s[48:49], s[0:1], 128
    v_and_b32 v1, 63, v0
    v_lshrrev_b32 v12, 6, v0
    s_nop 0
    v_readfirstlane_b32 s3, v12
    v_lshlrev_b32 v3, 2, v1
    v_mov_b32 v10, 0
    v_mov_b32 v0, 44928
    s_cmp_lg_u32 s3, 7
    s_cbranch_scc1 L_p1
    s_getpc_b64 s[90:91]
L_pc:
    s_bfe_u32 s51, s2, 0x20003
    s_lshl_b32 s51, s51, 13
    v_lshl_add_u32 v112, v1, 7, s51
    v_min_u32 v112, L_last-L_pc, v112
    v_mov_b32 v113, s91
    v_add_co_u32 v112, vcc, s90, v112
    s_nop 1
    v_addc_co_u32 v113, vcc, 0, v113, vcc
    global_load_dword v114, v[112:113], off
    s_mov_b32 exec_hi, 0
    ds_write_b32 v3, v10 offset:44928
    s_mov_b64 exec, -1
    s_waitcnt lgkmcnt(0)
    s_load_dword s10, s[48:49], 0
    s_branch L_p3
L_end0:
    s_endpgm
L_p1:
    s_cmp_ge_u32 s3, 4
    s_cbranch_scc1 L_p2
    v_lshrrev_b32 v120, 5, v1
    v_mul_u32_u24 v121, 1280, v120
    v_and_b32 v122, 31, v1
    v_lshl_add_u32 v123, v122, 4, v121
    v_lshl_add_u32 v124, v122, 3, v121
    s_lshl_b32 s50, s2, 3
    s_lshl1_add_u32 s50, s3, s50
    s_mul_i32 s50, s50, 1280
    s_mov_b32 s54, 2621440
    s_mov_b32 s55, 0x20000
    s_waitcnt lgkmcnt(0)
    s_mov_b32 s52, s16
    s_mov_b32 s53, s17
    buffer_load_dwordx4 v[20:23], v123, s[52:55], s50 offen
    buffer_load_dwordx4 v[24:27], v123, s[52:55], s50 offen offset:512
    buffer_load_dwordx2 v[28:29], v124, s[52:55], s50 offen offset:1024
    s_branch L_p3
L_p2:
    s_and_b32 s4, s2, 7
    s_lshr_b32 s5, s2, 3
    s_lshr_b32 s97, s4, 1
    s_and_b32 s12, s4, 1
    s_min_u32 s15, s5, 29
    s_mul_i32 s7, s15, 52
    s_lshr_b32 s7, s7, 8
    s_mul_i32 s51, s7, 5
    s_sub_u32 s11, s15, s51
    s_mul_i32 s98, s7, 3
    s_min_u32 s98, s98, 14
    s_cmp_lt_u32 s7, 4
    s_cselect_b32 s99, 3, 2
    s_cmp_ge_u32 s5, 30
    s_cselect_b32 s99, 0, s99
    s_mul_i32 s51, s12, 5
    s_add_u32 s6, s11, s51
    s_mul_i32 s51, s97, 6
    s_add_u32 s7, s7, s51
    s_sub_u32 s14, s3, 4
    s_cmp_ge_u32 s14, s99
    s_cbranch_scc1 L_end0
    s_lshl_b32 s13, s6, 6
    s_lshl4_add_u32 s13, s97, s13
    s_add_u32 s13, s13, s98
    s_add_u32 s13, s13, s14
    s_mul_i32 s51, s13, 384
    v_add_u32 v110, s51, v3
    v_lshl_add_u32 v111, v1, 1, s51
    s_lshr_b32 s79, s13, 1
    s_lshl_b32 s79, s79, 2
    s_waitcnt lgkmcnt(0)
    global_load_dword v4, v110, s[18:19] nt
    global_load_ushort v5, v111, s[18:19] offset:256 nt
    global_load_dword v6, v110, s[20:21] nt
    global_load_ushort v7, v111, s[20:21] offset:256 nt
    global_load_dword v8, v110, s[22:23] nt
    global_load_ushort v12, v111, s[22:23] offset:256 nt
    global_load_dword v13, v110, s[24:25] nt
    global_load_ushort v14, v111, s[24:25] offset:256 nt
    global_load_dword v15, v110, s[26:27] nt
    global_load_ushort v16, v111, s[26:27] offset:256 nt
    global_load_dword v17, v110, s[28:29] nt
    global_load_ushort v18, v111, s[28:29] offset:256 nt
    s_load_dword s80, s[30:31], s79
    s_load_dword s81, s[32:33], s79
L_p3:
    s_barrier
    v_lshlrev_b32 v2, 4, v1
    v_mov_b32 v11, 0
    s_and_b32 s4, s2, 7
    s_lshr_b32 s5, s2, 3
    s_lshr_b32 s97, s4, 1
    s_and_b32 s12, s4, 1
    s_min_u32 s15, s5, 29
    s_mul_i32 s7, s15, 52
    s_lshr_b32 s7, s7, 8
    s_mul_i32 s51, s7, 5
    s_sub_u32 s11, s15, s51
    s_mul_i32 s98, s7, 3
    s_min_u32 s98, s98, 14
    s_cmp_lt_u32 s7, 4
    s_cselect_b32 s99, 3, 2
    s_cmp_ge_u32 s5, 30
    s_cselect_b32 s99, 0, s99
    s_mul_i32 s51, s12, 5
    s_add_u32 s6, s11, s51
    s_mul_i32 s51, s97, 6
    s_add_u32 s7, s7, s51
    s_mov_b32 s68, s48
    s_mov_b32 s69, s49
    s_mov_b32 s70, 7733248
    s_mov_b32 s71, 0x20000
    s_mov_b32 s74, 0x864f25a0
    s_mov_b32 s75, 0xdb9731ec
    s_cmp_eq_u32 s11, 1
    s_cselect_b32 s74, 0xa08674c2, s74
    s_cselect_b32 s75, 0xfdb9153e, s75
    s_cmp_eq_u32 s11, 2
    s_cselect_b32 s74, 0xa20896e4, s74
    s_cselect_b32 s75, 0xfdb7315c, s75
    s_cmp_eq_u32 s11, 3
    s_cselect_b32 s74, 0xa420b186, s74
    s_cselect_b32 s75, 0xfd9753ec, s75
    s_cmp_eq_u32 s11, 4
    s_cselect_b32 s74, 0xa64d2308, s74
    s_cselect_b32 s75, 0xf7b951ec, s75
    s_mul_i32 s51, s12, 0x11111111
    s_xor_b32 s74, s74, s51
    s_xor_b32 s75, s75, s51
    s_and_b32 s8, s5, 3
    s_lshr_b32 s9, s5, 2
    s_xor_b32 s9, s9, 4
    s_lshl2_add_u32 s8, s12, s8
    s_lshl3_add_u32 s9, s97, s9
    s_cmp_ge_u32 s3, 4
    s_cbranch_scc1 L_aux
    s_setprio 3
    s_mul_i32 s73, s3, 28672
    s_add_u32 s73, s73, 45056
    s_mov_b32 s85, 0
    v_lshrrev_b32 v30, 3, v1
    v_and_b32 v31, 7, v1
    v_and_b32 v32, 2, v30
    v_xor_b32 v31, v31, v32
    v_lshlrev_b32 v31, 4, v31
    v_mul_u32_u24 v4, 3072, v30
    v_add_u32 v4, v4, v31
    v_xor_b32 v5, 64, v4
    v_lshl_add_u32 v12, v30, 12, v31
    v_xor_b32 v13, 64, v12
    s_mul_i32 s84, s3, 1572864
    s_lshl_b32 s51, s7, 7
    s_add_u32 s84, s84, s51
    s_mul_i32 s92, s3, 1572864
    s_lshl_b32 s51, s9, 7
    s_add_u32 s92, s92, s51
    s_mov_b32 s56, s36
    s_mov_b32 s57, s37
    s_mov_b32 s58, 6291456
    s_mov_b32 s59, 0x20000
    s_mov_b32 s60, s40
    s_mov_b32 s61, s41
    s_mov_b32 s62, 6291456
    s_mov_b32 s63, 0x20000
    s_mov_b32 s64, s44
    s_mov_b32 s65, s45
    s_mov_b32 s66, 2621440
    s_mov_b32 s67, 0x20000
    s_lshl_b32 s94, s9, 6
    s_lshl_b32 s51, s3, 4
    s_add_u32 s94, s94, s51
    s_lshl_b32 s95, s94, 1
    s_mul_i32 s94, s94, 1280
    s_mul_i32 s51, s8, 160
    s_add_u32 s94, s94, s51
    v_and_b32 v109, 15, v1
    v_mul_u32_u24 v109, 1280, v109
    v_and_b32 v108, 48, v1
    v_add_u32 v108, v108, v109
    buffer_load_dwordx4 v[104:107], v108, s[52:55], s94 offen offset:0
    buffer_load_dwordx4 v[110:113], v108, s[52:55], s94 offen offset:64
    buffer_load_dwordx4 v[116:119], v108, s[52:55], s94 offen offset:128
    s_bfe_u32 s72, s74, 0x40000
    s_mul_i32 s72, s72, 98304
    s_add_u32 s72, s72, s84
    s_add_u32 m0, s73, 0
    s_nop 0
    buffer_load_dwordx4 v4, s[56:59], s72 offen  lds
    s_add_u32 s72, s72, 24576
    s_add_u32 m0, s73, 1024
    s_nop 0
    buffer_load_dwordx4 v5, s[56:59], s72 offen  lds
    s_add_u32 s72, s72, 24576
    s_add_u32 m0, s73, 2048
    s_nop 0
    buffer_load_dwordx4 v4, s[56:59], s72 offen  lds
    s_add_u32 s72, s72, 24576
    s_add_u32 m0, s73, 3072
    s_nop 0
    buffer_load_dwordx4 v5, s[56:59], s72 offen  lds
    s_lshr_b32 s51, s3, 1
    s_mul_i32 s51, s51, 14976
    s_and_b32 s15, s3, 1
    s_mul_i32 s15, s15, 2688
    s_add_u32 s51, s51, s15
    s_add_u32 s51, s51, 8704
    v_mul_u32_u24 v102, 1344, v120
    v_add_u32 v102, s51, v102
    v_lshl_add_u32 v101, v122, 3, v102
    v_lshl_add_u32 v100, v122, 4, v102
    s_waitcnt vmcnt(7)
    v_lshlrev_b32 v30, 16, v20
    v_and_b32 v31, 0xffff0000, v20
    v_lshlrev_b32 v32, 16, v21
    v_and_b32 v33, 0xffff0000, v21
    v_lshlrev_b32 v34, 16, v22
    v_and_b32 v35, 0xffff0000, v22
    v_lshlrev_b32 v36, 16, v23
    v_and_b32 v37, 0xffff0000, v23
    v_lshlrev_b32 v38, 16, v24
    v_and_b32 v39, 0xffff0000, v24
    v_lshlrev_b32 v40, 16, v25
    v_and_b32 v41, 0xffff0000, v25
    v_lshlrev_b32 v42, 16, v26
    v_and_b32 v43, 0xffff0000, v26
    v_lshlrev_b32 v44, 16, v27
    v_and_b32 v45, 0xffff0000, v27
    v_lshlrev_b32 v46, 16, v28
    v_and_b32 v47, 0xffff0000, v28
    v_lshlrev_b32 v48, 16, v29
    v_and_b32 v49, 0xffff0000, v29
    v_pk_add_f32 v[70:71], v[30:31], v[32:33]
    v_pk_add_f32 v[72:73], v[34:35], v[36:37]
    v_pk_add_f32 v[70:71], v[70:71], v[38:39]
    v_pk_add_f32 v[72:73], v[72:73], v[40:41]
    v_pk_add_f32 v[70:71], v[70:71], v[42:43]
    v_pk_add_f32 v[72:73], v[72:73], v[44:45]
    v_pk_add_f32 v[70:71], v[70:71], v[46:47]
    v_pk_add_f32 v[72:73], v[72:73], v[48:49]
    v_pk_add_f32 v[70:71], v[70:71], v[72:73]
    v_add_f32 v70, v70, v71
    s_nop 1
    v_add_f32_dpp v70, v70, v70 quad_perm:[1,0,3,2] row_mask:0xf bank_mask:0xf
    s_nop 1
    v_add_f32_dpp v70, v70, v70 quad_perm:[2,3,0,1] row_mask:0xf bank_mask:0xf
    s_nop 1
    v_add_f32_dpp v70, v70, v70 row_half_mirror row_mask:0xf bank_mask:0xf
    s_nop 1
    v_add_f32_dpp v70, v70, v70 row_mirror row_mask:0xf bank_mask:0xf
    v_mov_b32 v72, v70
    s_nop 1
    v_permlane16_swap_b32 v70, v72
    v_add_f32 v70, v70, v72
    v_mul_f32 v70, 0x3acccccd, v70
    v_mov_b32 v74, v70
    v_cvt_pk_bf16_f32 v74, v74, v74
    v_lshlrev_b32 v74, 16, v74
    v_pk_add_f32 v[50:51], v[30:31], v[74:75] op_sel_hi:[1,0] neg_lo:[0,1] neg_hi:[0,1]
    v_pk_add_f32 v[52:53], v[32:33], v[74:75] op_sel_hi:[1,0] neg_lo:[0,1] neg_hi:[0,1]
    v_pk_add_f32 v[54:55], v[34:35], v[74:75] op_sel_hi:[1,0] neg_lo:[0,1] neg_hi:[0,1]
    v_pk_add_f32 v[56:57], v[36:37], v[74:75] op_sel_hi:[1,0] neg_lo:[0,1] neg_hi:[0,1]
    v_pk_add_f32 v[58:59], v[38:39], v[74:75] op_sel_hi:[1,0] neg_lo:[0,1] neg_hi:[0,1]
    v_pk_add_f32 v[60:61], v[40:41], v[74:75] op_sel_hi:[1,0] neg_lo:[0,1] neg_hi:[0,1]
    v_pk_add_f32 v[62:63], v[42:43], v[74:75] op_sel_hi:[1,0] neg_lo:[0,1] neg_hi:[0,1]
    v_pk_add_f32 v[64:65], v[44:45], v[74:75] op_sel_hi:[1,0] neg_lo:[0,1] neg_hi:[0,1]
    v_pk_add_f32 v[66:67], v[46:47], v[74:75] op_sel_hi:[1,0] neg_lo:[0,1] neg_hi:[0,1]
    v_pk_add_f32 v[68:69], v[48:49], v[74:75] op_sel_hi:[1,0] neg_lo:[0,1] neg_hi:[0,1]
    v_sub_f32 v75, v70, v74
    v_pk_mul_f32 v[70:71], v[50:51], v[50:51]
    v_pk_mul_f32 v[72:73], v[52:53], v[52:53]
    v_pk_fma_f32 v[70:71], v[54:55], v[54:55], v[70:71]
    v_pk_fma_f32 v[72:73], v[56:57], v[56:57], v[72:73]
    v_pk_fma_f32 v[70:71], v[58:59], v[58:59], v[70:71]
    v_pk_fma_f32 v[72:73], v[60:61], v[60:61], v[72:73]
    v_pk_fma_f32 v[70:71], v[62:63], v[62:63], v[70:71]
    v_pk_fma_f32 v[72:73], v[64:65], v[64:65], v[72:73]
    v_pk_fma_f32 v[70:71], v[66:67], v[66:67], v[70:71]
    v_pk_fma_f32 v[72:73], v[68:69], v[68:69], v[72:73]
    v_pk_add_f32 v[70:71], v[70:71], v[72:73]
    v_add_f32 v70, v70, v71
    s_nop 1
    v_add_f32_dpp v70, v70, v70 quad_perm:[1,0,3,2] row_mask:0xf bank_mask:0xf
    s_nop 1
    v_add_f32_dpp v70, v70, v70 quad_perm:[2,3,0,1] row_mask:0xf bank_mask:0xf
    s_nop 1
    v_add_f32_dpp v70, v70, v70 row_half_mirror row_mask:0xf bank_mask:0xf
    s_nop 1
    v_add_f32_dpp v70, v70, v70 row_mirror row_mask:0xf bank_mask:0xf
    v_mov_b32 v72, v70
    s_nop 1
    v_permlane16_swap_b32 v70, v72
    v_add_f32 v70, v70, v72
    v_mul_f32 v70, 0x3acccccd, v70
    v_fma_f32 v70, -v75, v75, v70
    v_max_f32 v70, 0, v70
    v_cvt_pk_bf16_f32 v70, v70, v70
    v_lshlrev_b32 v70, 16, v70
    v_add_f32 v70, 0x3727c5ac, v70
    v_cvt_pk_bf16_f32 v70, v70, v70
    v_lshlrev_b32 v70, 16, v70
    v_sqrt_f32 v70, v70
    s_nop 0
    v_cvt_pk_bf16_f32 v70, v70, v70
    v_lshlrev_b32 v70, 16, v70
    v_rcp_f32 v76, v70
    s_nop 0
    v_pk_mul_f32 v[50:51], v[50:51], v[76:77] op_sel_hi:[1,0]
    v_pk_mul_f32 v[52:53], v[52:53], v[76:77] op_sel_hi:[1,0]
    v_pk_mul_f32 v[54:55], v[54:55], v[76:77] op_sel_hi:[1,0]
    v_pk_mul_f32 v[56:57], v[56:57], v[76:77] op_sel_hi:[1,0]
    v_pk_mul_f32 v[58:59], v[58:59], v[76:77] op_sel_hi:[1,0]
    v_pk_mul_f32 v[60:61], v[60:61], v[76:77] op_sel_hi:[1,0]
    v_pk_mul_f32 v[62:63], v[62:63], v[76:77] op_sel_hi:[1,0]
    v_pk_mul_f32 v[64:65], v[64:65], v[76:77] op_sel_hi:[1,0]
    v_pk_mul_f32 v[66:67], v[66:67], v[76:77] op_sel_hi:[1,0]
    v_pk_mul_f32 v[68:69], v[68:69], v[76:77] op_sel_hi:[1,0]
    v_cvt_pk_bf16_f32 v20, v50, v51
    v_cvt_pk_bf16_f32 v21, v52, v53
    v_cvt_pk_bf16_f32 v22, v54, v55
    v_cvt_pk_bf16_f32 v23, v56, v57
    v_cvt_pk_bf16_f32 v24, v58, v59
    v_cvt_pk_bf16_f32 v25, v60, v61
    v_cvt_pk_bf16_f32 v26, v62, v63
    v_cvt_pk_bf16_f32 v27, v64, v65
    v_cvt_pk_bf16_f32 v28, v66, v67
    v_cvt_pk_bf16_f32 v29, v68, v69
    v_lshlrev_b32 v30, 16, v20
    v_and_b32 v31, 0xffff0000, v20
    v_lshlrev_b32 v32, 16, v21
    v_and_b32 v33, 0xffff0000, v21
    v_lshlrev_b32 v34, 16, v22
    v_and_b32 v35, 0xffff0000, v22
    v_lshlrev_b32 v36, 16, v23
    v_and_b32 v37, 0xffff0000, v23
    v_lshlrev_b32 v38, 16, v24
    v_and_b32 v39, 0xffff0000, v24
    v_lshlrev_b32 v40, 16, v25
    v_and_b32 v41, 0xffff0000, v25
    v_lshlrev_b32 v42, 16, v26
    v_and_b32 v43, 0xffff0000, v26
    v_lshlrev_b32 v44, 16, v27
    v_and_b32 v45, 0xffff0000, v27
    v_lshlrev_b32 v46, 16, v28
    v_and_b32 v47, 0xffff0000, v28
    v_lshlrev_b32 v48, 16, v29
    v_and_b32 v49, 0xffff0000, v29
    v_pk_add_f32 v[70:71], v[30:31], v[32:33]
    v_pk_add_f32 v[72:73], v[34:35], v[36:37]
    v_pk_add_f32 v[70:71], v[70:71], v[38:39]
    v_pk_add_f32 v[72:73], v[72:73], v[40:41]
    v_pk_add_f32 v[70:71], v[70:71], v[42:43]
    v_pk_add_f32 v[72:73], v[72:73], v[44:45]
    v_pk_add_f32 v[70:71], v[70:71], v[46:47]
    v_pk_add_f32 v[72:73], v[72:73], v[48:49]
    v_pk_add_f32 v[70:71], v[70:71], v[72:73]
    v_add_f32 v70, v70, v71
    v_pk_mul_f32 v[74:75], v[30:31], v[30:31]
    v_pk_mul_f32 v[76:77], v[32:33], v[32:33]
    v_pk_fma_f32 v[74:75], v[34:35], v[34:35], v[74:75]
    v_pk_fma_f32 v[76:77], v[36:37], v[36:37], v[76:77]
    v_pk_fma_f32 v[74:75], v[38:39], v[38:39], v[74:75]
    v_pk_fma_f32 v[76:77], v[40:41], v[40:41], v[76:77]
    v_pk_fma_f32 v[74:75], v[42:43], v[42:43], v[74:75]
    v_pk_fma_f32 v[76:77], v[44:45], v[44:45], v[76:77]
    v_pk_fma_f32 v[74:75], v[46:47], v[46:47], v[74:75]
    v_pk_fma_f32 v[76:77], v[48:49], v[48:49], v[76:77]
    v_pk_add_f32 v[74:75], v[74:75], v[76:77]
    v_add_f32 v74, v74, v75
    v_add_f32_dpp v70, v70, v70 quad_perm:[1,0,3,2] row_mask:0xf bank_mask:0xf
    s_nop 0
    v_add_f32_dpp v74, v74, v74 quad_perm:[1,0,3,2] row_mask:0xf bank_mask:0xf
    v_add_f32_dpp v70, v70, v70 quad_perm:[2,3,0,1] row_mask:0xf bank_mask:0xf
    s_nop 0
    v_add_f32_dpp v74, v74, v74 quad_perm:[2,3,0,1] row_mask:0xf bank_mask:0xf
    v_add_f32_dpp v70, v70, v70 row_half_mirror row_mask:0xf bank_mask:0xf
    s_nop 0
    v_add_f32_dpp v74, v74, v74 row_half_mirror row_mask:0xf bank_mask:0xf
    v_add_f32_dpp v70, v70, v70 row_mirror row_mask:0xf bank_mask:0xf
    s_nop 0
    v_add_f32_dpp v74, v74, v74 row_mirror row_mask:0xf bank_mask:0xf
    v_mov_b32 v72, v70
    v_mov_b32 v73, v74
    s_nop 0
    v_permlane16_swap_b32 v70, v72
    v_permlane16_swap_b32 v74, v73
    v_add_f32 v70, v70, v72
    v_add_f32 v74, v74, v73
    v_mul_f32 v70, 0x3acccccd, v70
    v_mul_f32 v74, 0x3acccccd, v74
    v_fma_f32 v74, -v70, v70, v74
    v_cvt_pk_bf16_f32 v70, v70, v70
    v_lshlrev_b32 v70, 16, v70
    v_max_f32 v74, 0, v74
    v_cvt_pk_bf16_f32 v74, v74, v74
    v_lshlrev_b32 v74, 16, v74
    v_add_f32 v74, 0x3727c5ac, v74
    v_cvt_pk_bf16_f32 v74, v74, v74
    v_lshlrev_b32 v74, 16, v74
    v_sqrt_f32 v74, v74
    s_nop 0
    v_cvt_pk_bf16_f32 v74, v74, v74
    v_lshlrev_b32 v74, 16, v74
    v_rcp_f32 v76, v74
    s_nop 0
    v_mul_f32 v72, v70, v76
    v_lshrrev_b32 v74, 16, v74
    v_or_b32 v74, v74, v70
    v_pk_fma_f32 v[50:51], v[30:31], v[76:77], v[72:73] op_sel_hi:[1,0,0] neg_lo:[0,0,1] neg_hi:[0,0,1]
    v_pk_fma_f32 v[52:53], v[32:33], v[76:77], v[72:73] op_sel_hi:[1,0,0] neg_lo:[0,0,1] neg_hi:[0,0,1]
    v_pk_fma_f32 v[54:55], v[34:35], v[76:77], v[72:73] op_sel_hi:[1,0,0] neg_lo:[0,0,1] neg_hi:[0,0,1]
    v_pk_fma_f32 v[56:57], v[36:37], v[76:77], v[72:73] op_sel_hi:[1,0,0] neg_lo:[0,0,1] neg_hi:[0,0,1]
    v_pk_fma_f32 v[58:59], v[38:39], v[76:77], v[72:73] op_sel_hi:[1,0,0] neg_lo:[0,0,1] neg_hi:[0,0,1]
    v_pk_fma_f32 v[60:61], v[40:41], v[76:77], v[72:73] op_sel_hi:[1,0,0] neg_lo:[0,0,1] neg_hi:[0,0,1]
    v_pk_fma_f32 v[62:63], v[42:43], v[76:77], v[72:73] op_sel_hi:[1,0,0] neg_lo:[0,0,1] neg_hi:[0,0,1]
    v_pk_fma_f32 v[64:65], v[44:45], v[76:77], v[72:73] op_sel_hi:[1,0,0] neg_lo:[0,0,1] neg_hi:[0,0,1]
    v_pk_fma_f32 v[66:67], v[46:47], v[76:77], v[72:73] op_sel_hi:[1,0,0] neg_lo:[0,0,1] neg_hi:[0,0,1]
    v_pk_fma_f32 v[68:69], v[48:49], v[76:77], v[72:73] op_sel_hi:[1,0,0] neg_lo:[0,0,1] neg_hi:[0,0,1]
    ds_write_b32 v102, v74 offset:1280
    v_cvt_pk_bf16_f32 v90, v50, v51
    v_cvt_pk_bf16_f32 v91, v52, v53
    v_cvt_pk_bf16_f32 v92, v54, v55
    v_cvt_pk_bf16_f32 v93, v56, v57
    v_cvt_pk_bf16_f32 v94, v58, v59
    v_cvt_pk_bf16_f32 v95, v60, v61
    v_cvt_pk_bf16_f32 v96, v62, v63
    v_cvt_pk_bf16_f32 v97, v64, v65
    v_cvt_pk_bf16_f32 v98, v66, v67
    v_cvt_pk_bf16_f32 v99, v68, v69
    ds_write_b128 v100, v[90:93]
    ds_write_b128 v100, v[94:97] offset:512
    ds_write_b64 v101, v[98:99] offset:1024
    v_mov_b32 v70, 1
    s_mov_b64 exec, 1
    ds_add_u32 v0, v70 offset:0
    s_mov_b64 exec, -1
    s_setprio 2
    v_bfe_u32 v20, v1, 2, 2
    v_and_b32 v21, 3, v1
    v_lshrrev_b32 v22, 4, v1
    v_and_b32 v23, 15, v1
    v_lshlrev_b32 v24, 10, v22
    v_lshl_add_u32 v24, v20, 7, v24
    v_lshl_add_u32 v24, v21, 3, v24
    v_lshrrev_b32 v20, 1, v20
    v_and_b32 v21, 1, v22
    v_lshl_or_b32 v20, v21, 1, v20
    v_xor_b32 v20, s3, v20
    v_lshlrev_b32 v20, 5, v20
    v_add3_u32 v14, v24, v20, s73
    v_xor_b32 v15, 32, v14
    v_xor_b32 v16, 64, v14
    v_xor_b32 v17, 0x60, v14
    s_lshl_b32 s51, s7, 7
    s_lshl_b32 s15, s3, 5
    s_add_u32 s51, s51, s15
    v_lshl_add_u32 v24, v22, 3, s51
    global_load_dwordx2 v[126:127], v24, s[38:39]
    v_mul_u32_u24 v19, 10240, v22
    v_lshl_add_u32 v19, v23, 4, v19
    s_lshl_b32 s51, s97, 8
    v_add_u32 v120, s51, v19
    v_xor_b32 v121, 0x100, v120
    v_xor_b32 v122, 0x200, v120
    v_xor_b32 v123, 0x300, v120
    v_lshrrev_b32 v24, 1, v22
    v_mul_u32_u24 v24, 10240, v24
    v_lshl_add_u32 v24, v23, 4, v24
    v_xor_b32 v25, s97, v21
    v_lshl_add_u32 v6, v25, 8, v24
    v_xor_b32 v7, 0x200, v6
    v_subrev_u32 v124, s98, v23
    v_mul_u32_u24 v124, 14976, v124
    v_lshl_add_u32 v124, v22, 4, v124
    s_lshl_b32 s51, s3, 10
    s_add_u32 s51, s51, 10880
    v_add_u32 v124, s51, v124
    s_bfm_b32 s100, s99, s98
    s_lshl_b32 s51, s100, 16
    s_or_b32 s100, s100, s51
    s_mov_b32 s101, s100
    v_mul_u32_u24 v18, 1280, v23
    v_lshl_add_u32 v18, v22, 3, v18
    v_lshlrev_b32 v115, 12, v23
    v_lshl_add_u32 v115, v22, 4, v115
    v_lshl_add_u32 v8, v23, 1, s95
    global_load_ushort v114, v8, s[42:43]
    s_and_b32 s15, s5, 3
    s_mov_b32 s80, 0x31645280
    s_mov_b32 s81, 0xb97a
    s_cmp_eq_u32 s15, 1
    s_cselect_b32 s80, 0x830764a2, s80
    s_cselect_b32 s81, 0xb951, s81
    s_cmp_eq_u32 s15, 2
    s_cselect_b32 s80, 0xa8920614, s80
    s_cselect_b32 s81, 0xb753, s81
    s_cmp_eq_u32 s15, 3
    s_cselect_b32 s80, 0xab842036, s80
    s_cselect_b32 s81, 0x9751, s81
    s_and_b32 s15, s9, 0
    s_and_b32 s51, s4, 1
    s_xor_b32 s51, s51, s15
    s_mul_i32 s51, s51, 0x11111111
    s_xor_b32 s80, s80, s51
    s_xor_b32 s81, s81, s51
    s_mul_i32 s86, s3, 655360
    s_lshl_b32 s51, s6, 10
    s_add_u32 s86, s86, s51
    s_add_u32 s86, s86, 524288
    s_cmp_lt_u32 s5, 30
    s_cbranch_scc1 L_g1
    s_waitcnt vmcnt(0)
    v_lshlrev_b32 v114, 16, v114
    v_mov_b32 v84, v114
    v_mov_b32 v85, v114
    v_mov_b32 v86, v114
    v_mov_b32 v87, v114
    v_mov_b32 v88, v114
    v_mov_b32 v89, v114
    v_mov_b32 v90, v114
    v_mov_b32 v91, v114
    v_mov_b32 v92, v114
    v_mov_b32 v93, v114
    v_mov_b32 v94, v114
    v_mov_b32 v95, v114
    v_mov_b32 v96, v114
    v_mov_b32 v97, v114
    v_mov_b32 v98, v114
    v_mov_b32 v99, v114
    v_mov_b32 v100, v114
    v_mov_b32 v101, v114
    v_mov_b32 v102, v114
    v_mov_b32 v103, v114
    v_lshrrev_b32 v22, 4, v1
    v_and_b32 v23, 15, v1
    v_lshlrev_b32 v24, 3, v22
    v_sub_u32 v24, v23, v24
    v_and_b32 v25, 1, v24
    v_lshlrev_b32 v25, 4, v25
    v_mov_b32 v26, 0x3f80
    v_lshlrev_b32 v25, v25, v26
    v_ashrrev_i32 v24, 1, v24
    v_cmp_eq_u32 vcc, 0, v24
    s_nop 1
    v_cndmask_b32 v120, 0, v25, vcc
    v_cmp_eq_u32 vcc, 1, v24
    s_nop 1
    v_cndmask_b32 v121, 0, v25, vcc
    v_cmp_eq_u32 vcc, 2, v24
    s_nop 1
    v_cndmask_b32 v122, 0, v25, vcc
    v_cmp_eq_u32 vcc, 3, v24
    s_nop 1
    v_cndmask_b32 v123, 0, v25, vcc
    v_cmp_eq_i32 vcc, -8, v24
    s_nop 1
    v_cndmask_b32 v124, 0, v25, vcc
    v_cmp_eq_i32 vcc, -7, v24
    s_nop 1
    v_cndmask_b32 v125, 0, v25, vcc
    v_cmp_eq_i32 vcc, -6, v24
    s_nop 1
    v_cndmask_b32 v126, 0, v25, vcc
    v_cmp_eq_i32 vcc, -5, v24
    s_nop 1
    v_cndmask_b32 v127, 0, v25, vcc
    v_mfma_f32_16x16x32_bf16 v[84:87], v[120:123], v[104:107], v[84:87]
    s_nop 0
    v_mfma_f32_16x16x32_bf16 v[88:91], v[124:127], v[104:107], v[88:91]
    v_mfma_f32_16x16x32_bf16 v[92:95], v[120:123], v[110:113], v[92:95]
    v_mfma_f32_16x16x32_bf16 v[96:99], v[124:127], v[110:113], v[96:99]
    v_mfma_f32_16x16x32_bf16 v[100:103], v[120:123], v[116:119], v[100:103]
    s_and_b32 s51, s3, 1
    s_cmp_eq_u32 s51, 0
    s_cbranch_scc1 Lnsw_1
    v_swap_b32 v120, v124
    v_swap_b32 v121, v125
    v_swap_b32 v122, v126
    v_swap_b32 v123, v127
Lnsw_1:
    s_mov_b32 s78, 0
    s_branch Lspinf_4
Lspin_2:
    s_sleep 4
Lspinf_4:
    ds_read_b32 v20, v0 offset:16
    s_add_u32 s78, s78, 1
    s_waitcnt lgkmcnt(0)
    v_readfirstlane_b32 s79, v20
    s_cmp_gt_u32 s78, 0x200000
    s_cbranch_scc1 Lspind_3
    s_cmp_lt_u32 s79, 2
    s_cbranch_scc1 Lspin_2
Lspind_3:
    s_bfe_u32 s72, s80, 0x40000
    s_mul_i32 s72, s72, 131072
    s_add_u32 s72, s72, s92
    s_add_u32 m0, s73, 12288
    s_nop 0
    buffer_load_dwordx4 v12, s[60:63], s72 offen  lds
    s_add_u32 s72, s72, 32768
    s_add_u32 m0, s73, 13312
    s_nop 0
    buffer_load_dwordx4 v13, s[60:63], s72 offen  lds
    s_add_u32 s72, s72, 32768
    s_add_u32 m0, s73, 14336
    s_nop 0
    buffer_load_dwordx4 v12, s[60:63], s72 offen  lds
    s_add_u32 s72, s72, 32768
    s_add_u32 m0, s73, 15360
    s_nop 0
    buffer_load_dwordx4 v13, s[60:63], s72 offen  lds
    s_bfe_u32 s72, s80, 0x40004
    s_mul_i32 s72, s72, 131072
    s_add_u32 s72, s72, s92
    s_add_u32 m0, s73, 16384
    s_nop 0
    buffer_load_dwordx4 v12, s[60:63], s72 offen  lds
    s_add_u32 s72, s72, 32768
    s_add_u32 m0, s73, 17408
    s_nop 0
    buffer_load_dwordx4 v13, s[60:63], s72 offen  lds
    s_add_u32 s72, s72, 32768
    s_add_u32 m0, s73, 18432
    s_nop 0
    buffer_load_dwordx4 v12, s[60:63], s72 offen  lds
    s_add_u32 s72, s72, 32768
    s_add_u32 m0, s73, 19456
    s_nop 0
    buffer_load_dwordx4 v13, s[60:63], s72 offen  lds
    s_waitcnt vmcnt(4)
    ds_read_b64_tr_b16 a[0:1], v14 offset:12288
    ds_read_b64_tr_b16 a[2:3], v14 offset:12800
    ds_read_b64_tr_b16 a[4:5], v15 offset:12288
    ds_read_b64_tr_b16 a[6:7], v15 offset:12800
    ds_read_b64_tr_b16 a[8:9], v16 offset:12288
    ds_read_b64_tr_b16 a[10:11], v16 offset:12800
    ds_read_b64_tr_b16 a[12:13], v17 offset:12288
    ds_read_b64_tr_b16 a[14:15], v17 offset:12800
    s_waitcnt vmcnt(0)
    ds_read_b64_tr_b16 a[16:17], v14 offset:16384
    ds_read_b64_tr_b16 a[18:19], v14 offset:16896
    ds_read_b64_tr_b16 a[20:21], v15 offset:16384
    ds_read_b64_tr_b16 a[22:23], v15 offset:16896
    ds_read_b64_tr_b16 a[24:25], v16 offset:16384
    ds_read_b64_tr_b16 a[26:27], v16 offset:16896
    ds_read_b64_tr_b16 a[28:29], v17 offset:16384
    ds_read_b64_tr_b16 a[30:31], v17 offset:16896
    v_mov_b32 v20, 1
    s_mov_b64 exec, 1
    ds_add_u32 v0, v20 offset:24
    s_mov_b64 exec, -1
    s_waitcnt vmcnt(0) lgkmcnt(0)
    s_branch L_g2
L_g1:
    s_bfe_u32 s72, s74, 0x40004
    s_mul_i32 s72, s72, 98304
    s_add_u32 s72, s72, s84
    s_cmp_lg_u32 s85, 0
    s_cbranch_scc1 Lthr_5
    ds_read_b32 v20, v0 offset:16
    s_waitcnt vmcnt(4) lgkmcnt(0)
    v_readfirstlane_b32 s85, v20
    s_nop 0
    s_lshr_b32 s85, s85, 1
Lthr_5:
    s_add_u32 m0, s73, 4096
    s_nop 0
    buffer_load_dwordx4 v4, s[56:59], s72 offen  lds
    s_add_u32 s72, s72, 24576
    s_add_u32 m0, s73, 5120
    s_nop 0
    buffer_load_dwordx4 v5, s[56:59], s72 offen  lds
    s_add_u32 s72, s72, 24576
    s_cmp_lg_u32 s85, 0
    s_cbranch_scc1 Lthr_6
    ds_read_b32 v20, v0 offset:16
    s_waitcnt vmcnt(4) lgkmcnt(0)
    v_readfirstlane_b32 s85, v20
    s_nop 0
    s_lshr_b32 s85, s85, 1
Lthr_6:
    s_add_u32 m0, s73, 6144
    s_nop 0
    buffer_load_dwordx4 v4, s[56:59], s72 offen  lds
    s_add_u32 s72, s72, 24576
    s_add_u32 m0, s73, 7168
    s_nop 0
    buffer_load_dwordx4 v5, s[56:59], s72 offen  lds
    s_bfe_u32 s72, s74, 0x40008
    s_mul_i32 s72, s72, 98304
    s_add_u32 s72, s72, s84
    s_cmp_lg_u32 s85, 0
    s_cbranch_scc1 Lthr_7
    ds_read_b32 v20, v0 offset:16
    s_waitcnt vmcnt(4) lgkmcnt(0)
    v_readfirstlane_b32 s85, v20
    s_nop 0
    s_lshr_b32 s85, s85, 1
Lthr_7:
    s_add_u32 m0, s73, 8192
    s_nop 0
    buffer_load_dwordx4 v4, s[56:59], s72 offen  lds
    s_add_u32 s72, s72, 24576
    s_add_u32 m0, s73, 9216
    s_nop 0
    buffer_load_dwordx4 v5, s[56:59], s72 offen  lds
    s_add_u32 s72, s72, 24576
    s_cmp_lg_u32 s85, 0
    s_cbranch_scc1 Lthr_8
    ds_read_b32 v20, v0 offset:16
    s_waitcnt vmcnt(4) lgkmcnt(0)
    v_readfirstlane_b32 s85, v20
    s_nop 0
    s_lshr_b32 s85, s85, 1
Lthr_8:
    s_add_u32 m0, s73, 10240
    s_nop 0
    buffer_load_dwordx4 v4, s[56:59], s72 offen  lds
    s_add_u32 s72, s72, 24576
    s_add_u32 m0, s73, 11264
    s_nop 0
    buffer_load_dwordx4 v5, s[56:59], s72 offen  lds
    s_bfe_u32 s72, s74, 0x4000c
    s_mul_i32 s72, s72, 98304
    s_add_u32 s72, s72, s84
    s_cmp_lg_u32 s85, 0
    s_cbranch_scc1 Lthr_9
    ds_read_b32 v20, v0 offset:16
    s_waitcnt vmcnt(4) lgkmcnt(0)
    v_readfirstlane_b32 s85, v20
    s_nop 0
    s_lshr_b32 s85, s85, 1
Lthr_9:
    s_add_u32 m0, s73, 12288
    s_nop 0
    buffer_load_dwordx4 v4, s[56:59], s72 offen  lds
    s_add_u32 s72, s72, 24576
    s_add_u32 m0, s73, 13312
    s_nop 0
    buffer_load_dwordx4 v5, s[56:59], s72 offen  lds
    s_add_u32 s72, s72, 24576
    s_cmp_lg_u32 s85, 0
    s_cbranch_scc1 Lthr_10
    ds_read_b32 v20, v0 offset:16
    s_waitcnt vmcnt(4) lgkmcnt(0)
    v_readfirstlane_b32 s85, v20
    s_nop 0
    s_lshr_b32 s85, s85, 1
Lthr_10:
    s_add_u32 m0, s73, 14336
    s_nop 0
    buffer_load_dwordx4 v4, s[56:59], s72 offen  lds
    s_add_u32 s72, s72, 24576
    s_add_u32 m0, s73, 15360
    s_nop 0
    buffer_load_dwordx4 v5, s[56:59], s72 offen  lds
    s_waitcnt vmcnt(12)
    v_lshlrev_b32 v72, 16, v126
    v_and_b32 v73, 0xffff0000, v126
    v_lshlrev_b32 v74, 16, v127
    v_and_b32 v75, 0xffff0000, v127
    v_lshlrev_b32 v76, 16, v126
    v_and_b32 v77, 0xffff0000, v126
    v_lshlrev_b32 v78, 16, v127
    v_and_b32 v79, 0xffff0000, v127
    v_lshlrev_b32 v80, 16, v126
    v_and_b32 v81, 0xffff0000, v126
    v_lshlrev_b32 v82, 16, v127
    v_and_b32 v83, 0xffff0000, v127
    v_lshlrev_b32 v84, 16, v126
    v_and_b32 v85, 0xffff0000, v126
    v_lshlrev_b32 v86, 16, v127
    v_and_b32 v87, 0xffff0000, v127
    ds_read_b64_tr_b16 a[0:1], v14 offset:0
    ds_read_b64_tr_b16 a[2:3], v14 offset:512
    ds_read_b64_tr_b16 a[4:5], v15 offset:0
    ds_read_b64_tr_b16 a[6:7], v15 offset:512
    ds_read_b64_tr_b16 a[8:9], v16 offset:0
    ds_read_b64_tr_b16 a[10:11], v16 offset:512
    ds_read_b64_tr_b16 a[12:13], v17 offset:0
    ds_read_b64_tr_b16 a[14:15], v17 offset:512
    s_bfe_u32 s72, s74, 0x40010
    s_mul_i32 s72, s72, 98304
    s_add_u32 s72, s72, s84
    s_cmp_lg_u32 s85, 0
    s_cbranch_scc1 Lthr_11
    ds_read_b32 v20, v0 offset:16
    s_waitcnt vmcnt(4) lgkmcnt(0)
    v_readfirstlane_b32 s85, v20
    s_nop 0
    s_lshr_b32 s85, s85, 1
Lthr_11:
    s_add_u32 m0, s73, 16384
    s_nop 0
    buffer_load_dwordx4 v4, s[56:59], s72 offen  lds
    s_add_u32 s72, s72, 24576
    s_add_u32 m0, s73, 17408
    s_nop 0
    buffer_load_dwordx4 v5, s[56:59], s72 offen  lds
    s_add_u32 s72, s72, 24576
    s_cmp_lg_u32 s85, 0
    s_cbranch_scc1 Lthr_12
    ds_read_b32 v20, v0 offset:16
    s_waitcnt vmcnt(4) lgkmcnt(0)
    v_readfirstlane_b32 s85, v20
    s_nop 0
    s_lshr_b32 s85, s85, 1
Lthr_12:
    s_add_u32 m0, s73, 18432
    s_nop 0
    buffer_load_dwordx4 v4, s[56:59], s72 offen  lds
    s_add_u32 s72, s72, 24576
    s_add_u32 m0, s73, 19456
    s_nop 0
    buffer_load_dwordx4 v5, s[56:59], s72 offen  lds
    s_waitcnt vmcnt(12)
    ds_read_b64_tr_b16 a[16:17], v14 offset:4096
    ds_read_b64_tr_b16 a[18:19], v14 offset:4608
    ds_read_b64_tr_b16 a[20:21], v15 offset:4096
    ds_read_b64_tr_b16 a[22:23], v15 offset:4608
    ds_read_b64_tr_b16 a[24:25], v16 offset:4096
    ds_read_b64_tr_b16 a[26:27], v16 offset:4608
    ds_read_b64_tr_b16 a[28:29], v17 offset:4096
    ds_read_b64_tr_b16 a[30:31], v17 offset:4608
    s_bfe_u32 s72, s74, 0x40014
    s_mul_i32 s72, s72, 98304
    s_add_u32 s72, s72, s84
    s_cmp_lg_u32 s85, 0
    s_cbranch_scc1 Lthr_13
    ds_read_b32 v20, v0 offset:16
    s_waitcnt vmcnt(4) lgkmcnt(0)
    v_readfirstlane_b32 s85, v20
    s_nop 0
    s_lshr_b32 s85, s85, 1
Lthr_13:
    s_add_u32 m0, s73, 20480
    s_nop 0
    buffer_load_dwordx4 v4, s[56:59], s72 offen  lds
    s_add_u32 s72, s72, 24576
    s_add_u32 m0, s73, 21504
    s_nop 0
    buffer_load_dwordx4 v5, s[56:59], s72 offen  lds
    s_add_u32 s72, s72, 24576
    s_cmp_lg_u32 s85, 0
    s_cbranch_scc1 Lthr_14
    ds_read_b32 v20, v0 offset:16
    s_waitcnt vmcnt(4) lgkmcnt(0)
    v_readfirstlane_b32 s85, v20
    s_nop 0
    s_lshr_b32 s85, s85, 1
Lthr_14:
    s_add_u32 m0, s73, 22528
    s_nop 0
    buffer_load_dwordx4 v4, s[56:59], s72 offen  lds
    s_add_u32 s72, s72, 24576
    s_add_u32 m0, s73, 23552
    s_nop 0
    buffer_load_dwordx4 v5, s[56:59], s72 offen  lds
    s_waitcnt vmcnt(12)
    ds_read_b64_tr_b16 a[32:33], v14 offset:8192
    ds_read_b64_tr_b16 a[34:35], v14 offset:8704
    ds_read_b64_tr_b16 a[36:37], v15 offset:8192
    ds_read_b64_tr_b16 a[38:39], v15 offset:8704
    ds_read_b64_tr_b16 a[40:41], v16 offset:8192
    ds_read_b64_tr_b16 a[42:43], v16 offset:8704
    ds_read_b64_tr_b16 a[44:45], v17 offset:8192
    ds_read_b64_tr_b16 a[46:47], v17 offset:8704
    s_bfe_u32 s72, s74, 0x40018
    s_mul_i32 s72, s72, 98304
    s_add_u32 s72, s72, s84
    s_add_u32 m0, s73, 24576
    s_nop 0
    buffer_load_dwordx4 v4, s[56:59], s72 offen  lds
    s_add_u32 s72, s72, 24576
    s_add_u32 m0, s73, 25600
    s_nop 0
    buffer_load_dwordx4 v5, s[56:59], s72 offen  lds
    s_add_u32 s72, s72, 24576
    s_add_u32 m0, s73, 26624
    s_nop 0
    buffer_load_dwordx4 v4, s[56:59], s72 offen  lds
    s_add_u32 s72, s72, 24576
    s_add_u32 m0, s73, 27648
    s_nop 0
    buffer_load_dwordx4 v5, s[56:59], s72 offen  lds
    s_waitcnt vmcnt(12)
    ds_read_b64_tr_b16 a[48:49], v14 offset:12288
    ds_read_b64_tr_b16 a[50:51], v14 offset:12800
    ds_read_b64_tr_b16 a[52:53], v15 offset:12288
    ds_read_b64_tr_b16 a[54:55], v15 offset:12800
    ds_read_b64_tr_b16 a[56:57], v16 offset:12288
    ds_read_b64_tr_b16 a[58:59], v16 offset:12800
    ds_read_b64_tr_b16 a[60:61], v17 offset:12288
    ds_read_b64_tr_b16 a[62:63], v17 offset:12800
    s_waitcnt lgkmcnt(15)
    s_bfe_u32 s72, s74, 0x4001c
    s_mul_i32 s72, s72, 98304
    s_add_u32 s72, s72, s84
    s_add_u32 m0, s73, 0
    s_nop 0
    buffer_load_dwordx4 v4, s[56:59], s72 offen  lds
    s_add_u32 s72, s72, 24576
    s_add_u32 m0, s73, 1024
    s_nop 0
    buffer_load_dwordx4 v5, s[56:59], s72 offen  lds
    s_add_u32 s72, s72, 24576
    s_add_u32 m0, s73, 2048
    s_nop 0
    buffer_load_dwordx4 v4, s[56:59], s72 offen  lds
    s_add_u32 s72, s72, 24576
    s_add_u32 m0, s73, 3072
    s_nop 0
    buffer_load_dwordx4 v5, s[56:59], s72 offen  lds
    s_waitcnt vmcnt(12)
    ds_read_b64_tr_b16 a[64:65], v14 offset:16384
    ds_read_b64_tr_b16 a[66:67], v14 offset:16896
    ds_read_b64_tr_b16 a[68:69], v15 offset:16384
    ds_read_b64_tr_b16 a[70:71], v15 offset:16896
    ds_read_b64_tr_b16 a[72:73], v16 offset:16384
    ds_read_b64_tr_b16 a[74:75], v16 offset:16896
    ds_read_b64_tr_b16 a[76:77], v17 offset:16384
    ds_read_b64_tr_b16 a[78:79], v17 offset:16896
    s_bfe_u32 s72, s75, 0x40000
    s_mul_i32 s72, s72, 98304
    s_add_u32 s72, s72, s84
    s_add_u32 m0, s73, 4096
    s_nop 0
    buffer_load_dwordx4 v4, s[56:59], s72 offen  lds
    s_add_u32 s72, s72, 24576
    s_add_u32 m0, s73, 5120
    s_nop 0
    buffer_load_dwordx4 v5, s[56:59], s72 offen  lds
    s_add_u32 s72, s72, 24576
    s_add_u32 m0, s73, 6144
    s_nop 0
    buffer_load_dwordx4 v4, s[56:59], s72 offen  lds
    s_add_u32 s72, s72, 24576
    s_add_u32 m0, s73, 7168
    s_nop 0
    buffer_load_dwordx4 v5, s[56:59], s72 offen  lds
    s_waitcnt vmcnt(12)
    ds_read_b64_tr_b16 a[80:81], v14 offset:20480
    ds_read_b64_tr_b16 a[82:83], v14 offset:20992
    ds_read_b64_tr_b16 a[84:85], v15 offset:20480
    ds_read_b64_tr_b16 a[86:87], v15 offset:20992
    ds_read_b64_tr_b16 a[88:89], v16 offset:20480
    ds_read_b64_tr_b16 a[90:91], v16 offset:20992
    ds_read_b64_tr_b16 a[92:93], v17 offset:20480
    ds_read_b64_tr_b16 a[94:95], v17 offset:20992
    s_waitcnt lgkmcnt(15)
    s_bfe_u32 s72, s75, 0x40004
    s_mul_i32 s72, s72, 98304
    s_add_u32 s72, s72, s84
    s_add_u32 m0, s73, 8192
    s_nop 0
    buffer_load_dwordx4 v4, s[56:59], s72 offen  lds
    s_add_u32 s72, s72, 24576
    s_add_u32 m0, s73, 9216
    s_nop 0
    buffer_load_dwordx4 v5, s[56:59], s72 offen  lds
    s_add_u32 s72, s72, 24576
    s_add_u32 m0, s73, 10240
    s_nop 0
    buffer_load_dwordx4 v4, s[56:59], s72 offen  lds
    s_add_u32 s72, s72, 24576
    s_add_u32 m0, s73, 11264
    s_nop 0
    buffer_load_dwordx4 v5, s[56:59], s72 offen  lds
    s_waitcnt vmcnt(12)
    s_bfe_u32 s72, s75, 0x40008
    s_mul_i32 s72, s72, 98304
    s_add_u32 s72, s72, s84
    s_add_u32 m0, s73, 12288
    s_nop 0
    buffer_load_dwordx4 v4, s[56:59], s72 offen  lds
    s_add_u32 s72, s72, 24576
    s_add_u32 m0, s73, 13312
    s_nop 0
    buffer_load_dwordx4 v5, s[56:59], s72 offen  lds
    s_add_u32 s72, s72, 24576
    s_add_u32 m0, s73, 14336
    s_nop 0
    buffer_load_dwordx4 v4, s[56:59], s72 offen  lds
    s_add_u32 s72, s72, 24576
    s_add_u32 m0, s73, 15360
    s_nop 0
    buffer_load_dwordx4 v5, s[56:59], s72 offen  lds
    v_mov_b32 v20, 1
    s_mov_b64 exec, 1
    ds_add_u32 v0, v20 offset:20
    s_mov_b64 exec, -1
    s_waitcnt vmcnt(12)
    s_waitcnt lgkmcnt(9)
    s_bfe_u32 s72, s75, 0x4000c
    s_mul_i32 s72, s72, 98304
    s_add_u32 s72, s72, s84
    s_add_u32 m0, s73, 16384
    s_nop 0
    buffer_load_dwordx4 v4, s[56:59], s72 offen  lds
    s_add_u32 s72, s72, 24576
    s_add_u32 m0, s73, 17408
    s_nop 0
    buffer_load_dwordx4 v5, s[56:59], s72 offen  lds
    s_add_u32 s72, s72, 24576
    s_add_u32 m0, s73, 18432
    s_nop 0
    buffer_load_dwordx4 v4, s[56:59], s72 offen  lds
    s_add_u32 s72, s72, 24576
    s_add_u32 m0, s73, 19456
    s_nop 0
    buffer_load_dwordx4 v5, s[56:59], s72 offen  lds
    s_waitcnt vmcnt(12)
    s_waitcnt lgkmcnt(1)
    s_bfe_u32 s72, s75, 0x40010
    s_mul_i32 s72, s72, 98304
    s_add_u32 s72, s72, s84
    s_add_u32 m0, s73, 20480
    s_nop 0
    buffer_load_dwordx4 v4, s[56:59], s72 offen  lds
    s_add_u32 s72, s72, 24576
    s_add_u32 m0, s73, 21504
    s_nop 0
    buffer_load_dwordx4 v5, s[56:59], s72 offen  lds
    s_add_u32 s72, s72, 24576
    s_add_u32 m0, s73, 22528
    s_nop 0
    buffer_load_dwordx4 v4, s[56:59], s72 offen  lds
    s_add_u32 s72, s72, 24576
    s_add_u32 m0, s73, 23552
    s_nop 0
    buffer_load_dwordx4 v5, s[56:59], s72 offen  lds
    s_mov_b32 s78, 0
    s_branch Lspinf_17
Lspin_15:
    s_sleep 1
Lspinf_17:
    ds_read_b32 v20, v0 offset:4
    s_add_u32 s78, s78, 1
    s_waitcnt lgkmcnt(0)
    v_readfirstlane_b32 s79, v20
    s_cmp_gt_u32 s78, 0x200000
    s_cbranch_scc1 Lspind_16
    s_cmp_lt_u32 s79, 1
    s_cbranch_scc1 Lspin_15
Lspind_16:
    ds_read_b32 v9, v0 offset:44
    s_setprio 2
    s_bfe_u32 s76, s74, 0x40000
    s_mul_i32 s76, s76, 40960
    s_add_u32 s76, s76, s86
    buffer_load_dwordx4 v[24:27], v120, s[68:71], s76 offen sc1
    buffer_load_dwordx4 v[28:31], v121, s[68:71], s76 offen sc1
    buffer_load_dwordx4 v[32:35], v122, s[68:71], s76 offen sc1
    buffer_load_dwordx4 v[36:39], v123, s[68:71], s76 offen sc1
    s_bfe_u32 s76, s74, 0x40004
    s_mul_i32 s76, s76, 40960
    s_add_u32 s76, s76, s86
    buffer_load_dwordx4 v[40:43], v120, s[68:71], s76 offen sc1
    buffer_load_dwordx4 v[44:47], v121, s[68:71], s76 offen sc1
    buffer_load_dwordx4 v[48:51], v122, s[68:71], s76 offen sc1
    buffer_load_dwordx4 v[52:55], v123, s[68:71], s76 offen sc1
    s_bfe_u32 s76, s74, 0x40008
    s_mul_i32 s76, s76, 40960
    s_add_u32 s76, s76, s86
    buffer_load_dwordx4 v[56:59], v120, s[68:71], s76 offen sc1
    buffer_load_dwordx4 v[60:63], v121, s[68:71], s76 offen sc1
    buffer_load_dwordx4 v[64:67], v122, s[68:71], s76 offen sc1
    buffer_load_dwordx4 v[68:71], v123, s[68:71], s76 offen sc1
    s_waitcnt vmcnt(11)
    v_mfma_f32_16x16x32_bf16 v[72:75], a[0:3], v[24:27], v[72:75]
    v_mfma_f32_16x16x32_bf16 v[88:91], a[4:7], v[24:27], 0
    s_bfe_u32 s14, s74, 0x40000
    s_bfe_u32 s76, s74, 0x4000c
    v_mfma_f32_16x16x32_bf16 a[96:99], a[8:11], v[24:27], 0
    v_lshl_add_u32 v125, s14, 6, v124
    s_mul_i32 s76, s76, 40960
    v_mfma_f32_16x16x32_bf16 a[112:115], a[12:15], v[24:27], 0
    s_mov_b64 exec, s[100:101]
    ds_write_b128 v125, v[24:27]
    s_mov_b64 exec, -1
    s_add_u32 s76, s76, s86
    s_waitcnt vmcnt(10)
    v_mfma_f32_16x16x32_bf16 v[76:79], a[0:3], v[28:31], v[76:79]
    buffer_load_dwordx4 v[24:27], v120, s[68:71], s76 offen sc1
    v_mfma_f32_16x16x32_bf16 v[92:95], a[4:7], v[28:31], 0
    v_mfma_f32_16x16x32_bf16 a[100:103], a[8:11], v[28:31], 0
    v_mfma_f32_16x16x32_bf16 a[116:119], a[12:15], v[28:31], 0
    s_waitcnt vmcnt(10)
    v_mfma_f32_16x16x32_bf16 v[80:83], a[0:3], v[32:35], v[80:83]
    buffer_load_dwordx4 v[28:31], v121, s[68:71], s76 offen sc1
    v_mfma_f32_16x16x32_bf16 v[96:99], a[4:7], v[32:35], 0
    v_mfma_f32_16x16x32_bf16 a[104:107], a[8:11], v[32:35], 0
    v_mfma_f32_16x16x32_bf16 a[120:123], a[12:15], v[32:35], 0
    s_waitcnt vmcnt(10)
    v_mfma_f32_16x16x32_bf16 v[84:87], a[0:3], v[36:39], v[84:87]
    buffer_load_dwordx4 v[32:35], v122, s[68:71], s76 offen sc1
    v_mfma_f32_16x16x32_bf16 v[100:103], a[4:7], v[36:39], 0
    v_mfma_f32_16x16x32_bf16 a[108:111], a[8:11], v[36:39], 0
    v_mfma_f32_16x16x32_bf16 a[124:127], a[12:15], v[36:39], 0
    s_waitcnt vmcnt(10)
    v_mfma_f32_16x16x32_bf16 v[72:75], a[16:19], v[40:43], v[72:75]
    buffer_load_dwordx4 v[36:39], v123, s[68:71], s76 offen sc1
    v_mfma_f32_16x16x32_bf16 v[88:91], a[20:23], v[40:43], v[88:91]
    s_bfe_u32 s14, s74, 0x40004
    s_bfe_u32 s76, s74, 0x40010
    v_mfma_f32_16x16x32_bf16 a[96:99], a[24:27], v[40:43], a[96:99]
    v_lshl_add_u32 v125, s14, 6, v124
    s_mul_i32 s76, s76, 40960
    v_mfma_f32_16x16x32_bf16 a[112:115], a[28:31], v[40:43], a[112:115]
    s_mov_b64 exec, s[100:101]
    ds_write_b128 v125, v[40:43]
    s_mov_b64 exec, -1
    s_add_u32 s76, s76, s86
    s_waitcnt vmcnt(10)
    v_mfma_f32_16x16x32_bf16 v[76:79], a[16:19], v[44:47], v[76:79]
    buffer_load_dwordx4 v[40:43], v120, s[68:71], s76 offen sc1
    v_mfma_f32_16x16x32_bf16 v[92:95], a[20:23], v[44:47], v[92:95]
    ds_read_b64_tr_b16 a[0:1], v14 offset:24576
    v_mfma_f32_16x16x32_bf16 a[100:103], a[24:27], v[44:47], a[100:103]
    ds_read_b64_tr_b16 a[2:3], v14 offset:25088
    ds_read_b64_tr_b16 a[4:5], v15 offset:24576
    v_mfma_f32_16x16x32_bf16 a[116:119], a[28:31], v[44:47], a[116:119]
    ds_read_b64_tr_b16 a[6:7], v15 offset:25088
    s_waitcnt vmcnt(10)
    v_mfma_f32_16x16x32_bf16 v[80:83], a[16:19], v[48:51], v[80:83]
    buffer_load_dwordx4 v[44:47], v121, s[68:71], s76 offen sc1
    v_mfma_f32_16x16x32_bf16 v[96:99], a[20:23], v[48:51], v[96:99]
    ds_read_b64_tr_b16 a[8:9], v16 offset:24576
    ds_read_b64_tr_b16 a[10:11], v16 offset:25088
    v_mfma_f32_16x16x32_bf16 a[104:107], a[24:27], v[48:51], a[104:107]
    ds_read_b64_tr_b16 a[12:13], v17 offset:24576
    ds_read_b64_tr_b16 a[14:15], v17 offset:25088
    v_mfma_f32_16x16x32_bf16 a[120:123], a[28:31], v[48:51], a[120:123]
    s_waitcnt vmcnt(10)
    v_mfma_f32_16x16x32_bf16 v[84:87], a[16:19], v[52:55], v[84:87]
    buffer_load_dwordx4 v[48:51], v122, s[68:71], s76 offen sc1
    v_mfma_f32_16x16x32_bf16 v[100:103], a[20:23], v[52:55], v[100:103]
    v_mfma_f32_16x16x32_bf16 a[108:111], a[24:27], v[52:55], a[108:111]
    v_mfma_f32_16x16x32_bf16 a[124:127], a[28:31], v[52:55], a[124:127]
    s_waitcnt vmcnt(10)
    v_mfma_f32_16x16x32_bf16 v[72:75], a[32:35], v[56:59], v[72:75]
    buffer_load_dwordx4 v[52:55], v123, s[68:71], s76 offen sc1
    v_mfma_f32_16x16x32_bf16 v[88:91], a[36:39], v[56:59], v[88:91]
    s_bfe_u32 s14, s74, 0x40008
    s_bfe_u32 s76, s74, 0x40014
    v_mfma_f32_16x16x32_bf16 a[96:99], a[40:43], v[56:59], a[96:99]
    v_lshl_add_u32 v125, s14, 6, v124
    s_mul_i32 s76, s76, 40960
    v_mfma_f32_16x16x32_bf16 a[112:115], a[44:47], v[56:59], a[112:115]
    s_mov_b64 exec, s[100:101]
    ds_write_b128 v125, v[56:59]
    s_mov_b64 exec, -1
    s_add_u32 s76, s76, s86
    s_waitcnt vmcnt(10)
    v_mfma_f32_16x16x32_bf16 v[76:79], a[32:35], v[60:63], v[76:79]
    s_waitcnt lgkmcnt(1)
    buffer_load_dwordx4 v[56:59], v120, s[68:71], s76 offen sc1
    v_mfma_f32_16x16x32_bf16 v[92:95], a[36:39], v[60:63], v[92:95]
    s_bfe_u32 s72, s75, 0x40014
    s_mul_i32 s72, s72, 98304
    s_add_u32 s72, s72, s84
    v_mfma_f32_16x16x32_bf16 a[100:103], a[40:43], v[60:63], a[100:103]
    s_add_u32 m0, s73, 24576
    s_nop 0
    buffer_load_dwordx4 v4, s[56:59], s72 offen  lds
    v_mfma_f32_16x16x32_bf16 a[116:119], a[44:47], v[60:63], a[116:119]
    s_add_u32 s72, s72, 24576
    s_waitcnt vmcnt(11)
    v_mfma_f32_16x16x32_bf16 v[80:83], a[32:35], v[64:67], v[80:83]
    buffer_load_dwordx4 v[60:63], v121, s[68:71], s76 offen sc1
    v_mfma_f32_16x16x32_bf16 v[96:99], a[36:39], v[64:67], v[96:99]
    s_add_u32 m0, s73, 25600
    s_nop 0
    buffer_load_dwordx4 v5, s[56:59], s72 offen  lds
    v_mfma_f32_16x16x32_bf16 a[104:107], a[40:43], v[64:67], a[104:107]
    s_add_u32 s72, s72, 24576
    v_mfma_f32_16x16x32_bf16 a[120:123], a[44:47], v[64:67], a[120:123]
    s_waitcnt vmcnt(12)
    v_mfma_f32_16x16x32_bf16 v[84:87], a[32:35], v[68:71], v[84:87]
    buffer_load_dwordx4 v[64:67], v122, s[68:71], s76 offen sc1
    v_mfma_f32_16x16x32_bf16 v[100:103], a[36:39], v[68:71], v[100:103]
    s_add_u32 m0, s73, 26624
    s_nop 0
    buffer_load_dwordx4 v4, s[56:59], s72 offen  lds
    v_mfma_f32_16x16x32_bf16 a[108:111], a[40:43], v[68:71], a[108:111]
    s_add_u32 s72, s72, 24576
    v_mfma_f32_16x16x32_bf16 a[124:127], a[44:47], v[68:71], a[124:127]
    s_add_u32 m0, s73, 27648
    s_nop 0
    buffer_load_dwordx4 v5, s[56:59], s72 offen  lds
    ds_read_b64_tr_b16 a[16:17], v14 offset:0
    ds_read_b64_tr_b16 a[18:19], v14 offset:512
    ds_read_b64_tr_b16 a[20:21], v15 offset:0
    ds_read_b64_tr_b16 a[22:23], v15 offset:512
    ds_read_b64_tr_b16 a[24:25], v16 offset:0
    ds_read_b64_tr_b16 a[26:27], v16 offset:512
    ds_read_b64_tr_b16 a[28:29], v17 offset:0
    ds_read_b64_tr_b16 a[30:31], v17 offset:512
    s_waitcnt vmcnt(14)
    v_mfma_f32_16x16x32_bf16 v[72:75], a[48:51], v[24:27], v[72:75]
    buffer_load_dwordx4 v[68:71], v123, s[68:71], s76 offen sc1
    v_mfma_f32_16x16x32_bf16 v[88:91], a[52:55], v[24:27], v[88:91]
    s_bfe_u32 s14, s74, 0x4000c
    s_bfe_u32 s76, s74, 0x40018
    v_mfma_f32_16x16x32_bf16 a[96:99], a[56:59], v[24:27], a[96:99]
    v_lshl_add_u32 v125, s14, 6, v124
    s_mul_i32 s76, s76, 40960
    v_mfma_f32_16x16x32_bf16 a[112:115], a[60:63], v[24:27], a[112:115]
    s_mov_b64 exec, s[100:101]
    ds_write_b128 v125, v[24:27]
    s_mov_b64 exec, -1
    s_add_u32 s76, s76, s86
    s_waitcnt vmcnt(14)
    v_mfma_f32_16x16x32_bf16 v[76:79], a[48:51], v[28:31], v[76:79]
    v_mov_b32 v20, 1
    buffer_load_dwordx4 v[24:27], v120, s[68:71], s76 offen sc1
    v_mfma_f32_16x16x32_bf16 v[92:95], a[52:55], v[28:31], v[92:95]
    s_mov_b64 exec, 1
    ds_add_u32 v0, v20 offset:48
    s_mov_b64 exec, -1
    s_waitcnt lgkmcnt(2)
    v_mfma_f32_16x16x32_bf16 a[100:103], a[56:59], v[28:31], a[100:103]
    s_bfe_u32 s72, s75, 0x40018
    s_mul_i32 s72, s72, 98304
    s_add_u32 s72, s72, s84
    v_mfma_f32_16x16x32_bf16 a[116:119], a[60:63], v[28:31], a[116:119]
    s_waitcnt vmcnt(14)
    v_mfma_f32_16x16x32_bf16 v[80:83], a[48:51], v[32:35], v[80:83]
    buffer_load_dwordx4 v[28:31], v121, s[68:71], s76 offen sc1
    v_mfma_f32_16x16x32_bf16 v[96:99], a[52:55], v[32:35], v[96:99]
    s_add_u32 m0, s73, 0
    s_nop 0
    buffer_load_dwordx4 v4, s[56:59], s72 offen  lds
    v_mfma_f32_16x16x32_bf16 a[104:107], a[56:59], v[32:35], a[104:107]
    s_add_u32 s72, s72, 24576
    v_mfma_f32_16x16x32_bf16 a[120:123], a[60:63], v[32:35], a[120:123]
    s_waitcnt vmcnt(15)
    v_mfma_f32_16x16x32_bf16 v[84:87], a[48:51], v[36:39], v[84:87]
    buffer_load_dwordx4 v[32:35], v122, s[68:71], s76 offen sc1
    v_mfma_f32_16x16x32_bf16 v[100:103], a[52:55], v[36:39], v[100:103]
    s_add_u32 m0, s73, 1024
    s_nop 0
    buffer_load_dwordx4 v5, s[56:59], s72 offen  lds
    v_mfma_f32_16x16x32_bf16 a[108:111], a[56:59], v[36:39], a[108:111]
    s_add_u32 s72, s72, 24576
    v_mfma_f32_16x16x32_bf16 a[124:127], a[60:63], v[36:39], a[124:127]
    s_add_u32 m0, s73, 2048
    s_nop 0
    buffer_load_dwordx4 v4, s[56:59], s72 offen  lds
    s_add_u32 s72, s72, 24576
    s_add_u32 m0, s73, 3072
    s_nop 0
    buffer_load_dwordx4 v5, s[56:59], s72 offen  lds
    ds_read_b64_tr_b16 a[32:33], v14 offset:4096
    ds_read_b64_tr_b16 a[34:35], v14 offset:4608
    ds_read_b64_tr_b16 a[36:37], v15 offset:4096
    ds_read_b64_tr_b16 a[38:39], v15 offset:4608
    ds_read_b64_tr_b16 a[40:41], v16 offset:4096
    ds_read_b64_tr_b16 a[42:43], v16 offset:4608
    ds_read_b64_tr_b16 a[44:45], v17 offset:4096
    ds_read_b64_tr_b16 a[46:47], v17 offset:4608
    s_waitcnt vmcnt(18)
    v_mfma_f32_16x16x32_bf16 v[72:75], a[64:67], v[40:43], v[72:75]
    buffer_load_dwordx4 v[36:39], v123, s[68:71], s76 offen sc1
    v_mfma_f32_16x16x32_bf16 v[88:91], a[68:71], v[40:43], v[88:91]
    s_bfe_u32 s14, s74, 0x40010
    s_bfe_u32 s76, s74, 0x4001c
    v_mfma_f32_16x16x32_bf16 a[96:99], a[72:75], v[40:43], a[96:99]
    v_lshl_add_u32 v125, s14, 6, v124
    s_mul_i32 s76, s76, 40960
    v_mfma_f32_16x16x32_bf16 a[112:115], a[76:79], v[40:43], a[112:115]
    s_mov_b64 exec, s[100:101]
    ds_write_b128 v125, v[40:43]
    s_mov_b64 exec, -1
    s_add_u32 s76, s76, s86
    s_waitcnt vmcnt(18)
    v_mfma_f32_16x16x32_bf16 v[76:79], a[64:67], v[44:47], v[76:79]
    s_waitcnt lgkmcnt(1)
    buffer_load_dwordx4 v[40:43], v120, s[68:71], s76 offen sc1
    v_mfma_f32_16x16x32_bf16 v[92:95], a[68:71], v[44:47], v[92:95]
    s_bfe_u32 s72, s75, 0x4001c
    s_mul_i32 s72, s72, 98304
    s_add_u32 s72, s72, s84
    v_mfma_f32_16x16x32_bf16 a[100:103], a[72:75], v[44:47], a[100:103]
    s_add_u32 m0, s73, 4096
    s_nop 0
    buffer_load_dwordx4 v4, s[56:59], s72 offen  lds
    v_mfma_f32_16x16x32_bf16 a[116:119], a[76:79], v[44:47], a[116:119]
    s_add_u32 s72, s72, 24576
    s_waitcnt vmcnt(19)
    v_mfma_f32_16x16x32_bf16 v[80:83], a[64:67], v[48:51], v[80:83]
    buffer_load_dwordx4 v[44:47], v121, s[68:71], s76 offen sc1
    v_mfma_f32_16x16x32_bf16 v[96:99], a[68:71], v[48:51], v[96:99]
    s_add_u32 m0, s73, 5120
    s_nop 0
    buffer_load_dwordx4 v5, s[56:59], s72 offen  lds
    v_mfma_f32_16x16x32_bf16 a[104:107], a[72:75], v[48:51], a[104:107]
    s_add_u32 s72, s72, 24576
    v_mfma_f32_16x16x32_bf16 a[120:123], a[76:79], v[48:51], a[120:123]
    s_waitcnt vmcnt(20)
    v_mfma_f32_16x16x32_bf16 v[84:87], a[64:67], v[52:55], v[84:87]
    buffer_load_dwordx4 v[48:51], v122, s[68:71], s76 offen sc1
    v_mfma_f32_16x16x32_bf16 v[100:103], a[68:71], v[52:55], v[100:103]
    s_add_u32 m0, s73, 6144
    s_nop 0
    buffer_load_dwordx4 v4, s[56:59], s72 offen  lds
    v_mfma_f32_16x16x32_bf16 a[108:111], a[72:75], v[52:55], a[108:111]
    s_add_u32 s72, s72, 24576
    v_mfma_f32_16x16x32_bf16 a[124:127], a[76:79], v[52:55], a[124:127]
    s_add_u32 m0, s73, 7168
    s_nop 0
    buffer_load_dwordx4 v5, s[56:59], s72 offen  lds
    ds_read_b64_tr_b16 a[48:49], v14 offset:8192
    ds_read_b64_tr_b16 a[50:51], v14 offset:8704
    ds_read_b64_tr_b16 a[52:53], v15 offset:8192
    ds_read_b64_tr_b16 a[54:55], v15 offset:8704
    ds_read_b64_tr_b16 a[56:57], v16 offset:8192
    ds_read_b64_tr_b16 a[58:59], v16 offset:8704
    ds_read_b64_tr_b16 a[60:61], v17 offset:8192
    ds_read_b64_tr_b16 a[62:63], v17 offset:8704
    s_waitcnt vmcnt(22)
    v_mfma_f32_16x16x32_bf16 v[72:75], a[80:83], v[56:59], v[72:75]
    buffer_load_dwordx4 v[52:55], v123, s[68:71], s76 offen sc1
    v_mfma_f32_16x16x32_bf16 v[88:91], a[84:87], v[56:59], v[88:91]
    s_bfe_u32 s14, s74, 0x40014
    s_bfe_u32 s76, s75, 0x40000
    v_mfma_f32_16x16x32_bf16 a[96:99], a[88:91], v[56:59], a[96:99]
    v_lshl_add_u32 v125, s14, 6, v124
    s_mul_i32 s76, s76, 40960
    v_mfma_f32_16x16x32_bf16 a[112:115], a[92:95], v[56:59], a[112:115]
    s_mov_b64 exec, s[100:101]
    ds_write_b128 v125, v[56:59]
    s_mov_b64 exec, -1
    s_add_u32 s76, s76, s86
    s_waitcnt vmcnt(21)
    v_mfma_f32_16x16x32_bf16 v[76:79], a[80:83], v[60:63], v[76:79]
    buffer_load_dwordx4 v[56:59], v120, s[68:71], s76 offen sc1
    v_mfma_f32_16x16x32_bf16 v[92:95], a[84:87], v[60:63], v[92:95]
    ds_read_b64_tr_b16 a[64:65], v14 offset:12288
    v_mfma_f32_16x16x32_bf16 a[100:103], a[88:91], v[60:63], a[100:103]
    ds_read_b64_tr_b16 a[66:67], v14 offset:12800
    ds_read_b64_tr_b16 a[68:69], v15 offset:12288
    v_mfma_f32_16x16x32_bf16 a[116:119], a[92:95], v[60:63], a[116:119]
    ds_read_b64_tr_b16 a[70:71], v15 offset:12800
    s_waitcnt vmcnt(20)
    v_mfma_f32_16x16x32_bf16 v[80:83], a[80:83], v[64:67], v[80:83]
    buffer_load_dwordx4 v[60:63], v121, s[68:71], s76 offen sc1
    v_mfma_f32_16x16x32_bf16 v[96:99], a[84:87], v[64:67], v[96:99]
    ds_read_b64_tr_b16 a[72:73], v16 offset:12288
    ds_read_b64_tr_b16 a[74:75], v16 offset:12800
    v_mfma_f32_16x16x32_bf16 a[104:107], a[88:91], v[64:67], a[104:107]
    ds_read_b64_tr_b16 a[76:77], v17 offset:12288
    ds_read_b64_tr_b16 a[78:79], v17 offset:12800
    v_mfma_f32_16x16x32_bf16 a[120:123], a[92:95], v[64:67], a[120:123]
    s_waitcnt vmcnt(18)
    v_mfma_f32_16x16x32_bf16 v[84:87], a[80:83], v[68:71], v[84:87]
    buffer_load_dwordx4 v[64:67], v122, s[68:71], s76 offen sc1
    v_mfma_f32_16x16x32_bf16 v[100:103], a[84:87], v[68:71], v[100:103]
    v_mfma_f32_16x16x32_bf16 a[108:111], a[88:91], v[68:71], a[108:111]
    v_mfma_f32_16x16x32_bf16 a[124:127], a[92:95], v[68:71], a[124:127]
    s_waitcnt vmcnt(18)
    v_mfma_f32_16x16x32_bf16 v[72:75], a[0:3], v[24:27], v[72:75]
    buffer_load_dwordx4 v[68:71], v123, s[68:71], s76 offen sc1
    v_mfma_f32_16x16x32_bf16 v[88:91], a[4:7], v[24:27], v[88:91]
    s_bfe_u32 s14, s74, 0x40018
    s_bfe_u32 s76, s75, 0x40004
    v_mfma_f32_16x16x32_bf16 a[96:99], a[8:11], v[24:27], a[96:99]
    v_lshl_add_u32 v125, s14, 6, v124
    s_mul_i32 s76, s76, 40960
    v_mfma_f32_16x16x32_bf16 a[112:115], a[12:15], v[24:27], a[112:115]
    s_mov_b64 exec, s[100:101]
    ds_write_b128 v125, v[24:27]
    s_mov_b64 exec, -1
    s_add_u32 s76, s76, s86
    s_waitcnt vmcnt(18)
    v_mfma_f32_16x16x32_bf16 v[76:79], a[0:3], v[28:31], v[76:79]
    buffer_load_dwordx4 v[24:27], v120, s[68:71], s76 offen sc1
    v_mfma_f32_16x16x32_bf16 v[92:95], a[4:7], v[28:31], v[92:95]
    ds_read_b64_tr_b16 a[80:81], v14 offset:16384
    v_mfma_f32_16x16x32_bf16 a[100:103], a[8:11], v[28:31], a[100:103]
    ds_read_b64_tr_b16 a[82:83], v14 offset:16896
    ds_read_b64_tr_b16 a[84:85], v15 offset:16384
    v_mfma_f32_16x16x32_bf16 a[116:119], a[12:15], v[28:31], a[116:119]
    ds_read_b64_tr_b16 a[86:87], v15 offset:16896
    s_waitcnt vmcnt(17)
    v_mfma_f32_16x16x32_bf16 v[80:83], a[0:3], v[32:35], v[80:83]
    buffer_load_dwordx4 v[28:31], v121, s[68:71], s76 offen sc1
    v_mfma_f32_16x16x32_bf16 v[96:99], a[4:7], v[32:35], v[96:99]
    ds_read_b64_tr_b16 a[88:89], v16 offset:16384
    ds_read_b64_tr_b16 a[90:91], v16 offset:16896
    v_mfma_f32_16x16x32_bf16 a[104:107], a[8:11], v[32:35], a[104:107]
    ds_read_b64_tr_b16 a[92:93], v17 offset:16384
    ds_read_b64_tr_b16 a[94:95], v17 offset:16896
    v_mfma_f32_16x16x32_bf16 a[120:123], a[12:15], v[32:35], a[120:123]
    s_waitcnt vmcnt(14)
    v_mfma_f32_16x16x32_bf16 v[84:87], a[0:3], v[36:39], v[84:87]
    buffer_load_dwordx4 v[32:35], v122, s[68:71], s76 offen sc1
    v_mfma_f32_16x16x32_bf16 v[100:103], a[4:7], v[36:39], v[100:103]
    v_mfma_f32_16x16x32_bf16 a[108:111], a[8:11], v[36:39], a[108:111]
    v_mfma_f32_16x16x32_bf16 a[124:127], a[12:15], v[36:39], a[124:127]
    s_waitcnt vmcnt(14)
    v_mfma_f32_16x16x32_bf16 v[72:75], a[16:19], v[40:43], v[72:75]
    buffer_load_dwordx4 v[36:39], v123, s[68:71], s76 offen sc1
    v_mfma_f32_16x16x32_bf16 v[88:91], a[20:23], v[40:43], v[88:91]
    s_bfe_u32 s14, s74, 0x4001c
    s_bfe_u32 s76, s75, 0x40008
    v_mfma_f32_16x16x32_bf16 a[96:99], a[24:27], v[40:43], a[96:99]
    v_lshl_add_u32 v125, s14, 6, v124
    s_mul_i32 s76, s76, 40960
    v_mfma_f32_16x16x32_bf16 a[112:115], a[28:31], v[40:43], a[112:115]
    s_mov_b64 exec, s[100:101]
    ds_write_b128 v125, v[40:43]
    s_mov_b64 exec, -1
    s_add_u32 s76, s76, s86
    s_waitcnt vmcnt(13)
    v_mfma_f32_16x16x32_bf16 v[76:79], a[16:19], v[44:47], v[76:79]
    buffer_load_dwordx4 v[40:43], v120, s[68:71], s76 offen sc1
    v_mfma_f32_16x16x32_bf16 v[92:95], a[20:23], v[44:47], v[92:95]
    v_mov_b32 v20, 1
    v_mfma_f32_16x16x32_bf16 a[100:103], a[24:27], v[44:47], a[100:103]
    s_mov_b64 exec, 1
    ds_add_u32 v0, v20 offset:52
    s_mov_b64 exec, -1
    v_mfma_f32_16x16x32_bf16 a[116:119], a[28:31], v[44:47], a[116:119]
    s_waitcnt vmcnt(12)
    v_mfma_f32_16x16x32_bf16 v[80:83], a[16:19], v[48:51], v[80:83]
    buffer_load_dwordx4 v[44:47], v121, s[68:71], s76 offen sc1
    v_mfma_f32_16x16x32_bf16 v[96:99], a[20:23], v[48:51], v[96:99]
    ds_read_b64_tr_b16 a[0:1], v14 offset:20480
    ds_read_b64_tr_b16 a[2:3], v14 offset:20992
    v_mfma_f32_16x16x32_bf16 a[104:107], a[24:27], v[48:51], a[104:107]
    ds_read_b64_tr_b16 a[4:5], v15 offset:20480
    ds_read_b64_tr_b16 a[6:7], v15 offset:20992
    v_mfma_f32_16x16x32_bf16 a[120:123], a[28:31], v[48:51], a[120:123]
    ds_read_b64_tr_b16 a[8:9], v16 offset:20480
    s_waitcnt vmcnt(10)
    v_mfma_f32_16x16x32_bf16 v[84:87], a[16:19], v[52:55], v[84:87]
    buffer_load_dwordx4 v[48:51], v122, s[68:71], s76 offen sc1
    v_mfma_f32_16x16x32_bf16 v[100:103], a[20:23], v[52:55], v[100:103]
    ds_read_b64_tr_b16 a[10:11], v16 offset:20992
    ds_read_b64_tr_b16 a[12:13], v17 offset:20480
    v_mfma_f32_16x16x32_bf16 a[108:111], a[24:27], v[52:55], a[108:111]
    ds_read_b64_tr_b16 a[14:15], v17 offset:20992
    v_mfma_f32_16x16x32_bf16 a[124:127], a[28:31], v[52:55], a[124:127]
    s_waitcnt vmcnt(10)
    v_mfma_f32_16x16x32_bf16 v[72:75], a[32:35], v[56:59], v[72:75]
    buffer_load_dwordx4 v[52:55], v123, s[68:71], s76 offen sc1
    v_mfma_f32_16x16x32_bf16 v[88:91], a[36:39], v[56:59], v[88:91]
    s_bfe_u32 s14, s75, 0x40000
    s_bfe_u32 s76, s75, 0x4000c
    v_mfma_f32_16x16x32_bf16 a[96:99], a[40:43], v[56:59], a[96:99]
    v_lshl_add_u32 v125, s14, 6, v124
    s_mul_i32 s76, s76, 40960
    v_mfma_f32_16x16x32_bf16 a[112:115], a[44:47], v[56:59], a[112:115]
    s_mov_b64 exec, s[100:101]
    ds_write_b128 v125, v[56:59]
    s_mov_b64 exec, -1
    s_add_u32 s76, s76, s86
    s_waitcnt vmcnt(10)
    v_mfma_f32_16x16x32_bf16 v[76:79], a[32:35], v[60:63], v[76:79]
    buffer_load_dwordx4 v[56:59], v120, s[68:71], s76 offen sc1
    v_mfma_f32_16x16x32_bf16 v[92:95], a[36:39], v[60:63], v[92:95]
    ds_read_b64_tr_b16 a[16:17], v14 offset:24576
    v_mfma_f32_16x16x32_bf16 a[100:103], a[40:43], v[60:63], a[100:103]
    ds_read_b64_tr_b16 a[18:19], v14 offset:25088
    ds_read_b64_tr_b16 a[20:21], v15 offset:24576
    v_mfma_f32_16x16x32_bf16 a[116:119], a[44:47], v[60:63], a[116:119]
    ds_read_b64_tr_b16 a[22:23], v15 offset:25088
    s_waitcnt vmcnt(10)
    v_mfma_f32_16x16x32_bf16 v[80:83], a[32:35], v[64:67], v[80:83]
    buffer_load_dwordx4 v[60:63], v121, s[68:71], s76 offen sc1
    v_mfma_f32_16x16x32_bf16 v[96:99], a[36:39], v[64:67], v[96:99]
    ds_read_b64_tr_b16 a[24:25], v16 offset:24576
    ds_read_b64_tr_b16 a[26:27], v16 offset:25088
    v_mfma_f32_16x16x32_bf16 a[104:107], a[40:43], v[64:67], a[104:107]
    ds_read_b64_tr_b16 a[28:29], v17 offset:24576
    ds_read_b64_tr_b16 a[30:31], v17 offset:25088
    v_mfma_f32_16x16x32_bf16 a[120:123], a[44:47], v[64:67], a[120:123]
    s_waitcnt vmcnt(10)
    v_mfma_f32_16x16x32_bf16 v[84:87], a[32:35], v[68:71], v[84:87]
    buffer_load_dwordx4 v[64:67], v122, s[68:71], s76 offen sc1
    v_mfma_f32_16x16x32_bf16 v[100:103], a[36:39], v[68:71], v[100:103]
    v_mfma_f32_16x16x32_bf16 a[108:111], a[40:43], v[68:71], a[108:111]
    v_mfma_f32_16x16x32_bf16 a[124:127], a[44:47], v[68:71], a[124:127]
    s_waitcnt lgkmcnt(15)
    s_waitcnt vmcnt(10)
    v_mfma_f32_16x16x32_bf16 v[72:75], a[48:51], v[24:27], v[72:75]
    buffer_load_dwordx4 v[68:71], v123, s[68:71], s76 offen sc1
    v_mfma_f32_16x16x32_bf16 v[88:91], a[52:55], v[24:27], v[88:91]
    s_bfe_u32 s14, s75, 0x40004
    s_bfe_u32 s76, s75, 0x40010
    v_mfma_f32_16x16x32_bf16 a[96:99], a[56:59], v[24:27], a[96:99]
    v_lshl_add_u32 v125, s14, 6, v124
    s_mul_i32 s76, s76, 40960
    v_mfma_f32_16x16x32_bf16 a[112:115], a[60:63], v[24:27], a[112:115]
    s_mov_b64 exec, s[100:101]
    ds_write_b128 v125, v[24:27]
    s_mov_b64 exec, -1
    s_add_u32 s76, s76, s86
    s_waitcnt vmcnt(10)
    v_mfma_f32_16x16x32_bf16 v[76:79], a[48:51], v[28:31], v[76:79]
    buffer_load_dwordx4 v[24:27], v120, s[68:71], s76 offen sc1
    v_mfma_f32_16x16x32_bf16 v[92:95], a[52:55], v[28:31], v[92:95]
    ds_read_b64_tr_b16 a[32:33], v14 offset:0
    v_mfma_f32_16x16x32_bf16 a[100:103], a[56:59], v[28:31], a[100:103]
    ds_read_b64_tr_b16 a[34:35], v14 offset:512
    ds_read_b64_tr_b16 a[36:37], v15 offset:0
    v_mfma_f32_16x16x32_bf16 a[116:119], a[60:63], v[28:31], a[116:119]
    ds_read_b64_tr_b16 a[38:39], v15 offset:512
    s_waitcnt vmcnt(10)
    v_mfma_f32_16x16x32_bf16 v[80:83], a[48:51], v[32:35], v[80:83]
    buffer_load_dwordx4 v[28:31], v121, s[68:71], s76 offen sc1
    v_mfma_f32_16x16x32_bf16 v[96:99], a[52:55], v[32:35], v[96:99]
    ds_read_b64_tr_b16 a[40:41], v16 offset:0
    ds_read_b64_tr_b16 a[42:43], v16 offset:512
    v_mfma_f32_16x16x32_bf16 a[104:107], a[56:59], v[32:35], a[104:107]
    ds_read_b64_tr_b16 a[44:45], v17 offset:0
    ds_read_b64_tr_b16 a[46:47], v17 offset:512
    v_mfma_f32_16x16x32_bf16 a[120:123], a[60:63], v[32:35], a[120:123]
    s_waitcnt vmcnt(10)
    v_mfma_f32_16x16x32_bf16 v[84:87], a[48:51], v[36:39], v[84:87]
    buffer_load_dwordx4 v[32:35], v122, s[68:71], s76 offen sc1
    v_mfma_f32_16x16x32_bf16 v[100:103], a[52:55], v[36:39], v[100:103]
    v_mfma_f32_16x16x32_bf16 a[108:111], a[56:59], v[36:39], a[108:111]
    v_mfma_f32_16x16x32_bf16 a[124:127], a[60:63], v[36:39], a[124:127]
    s_waitcnt vmcnt(10)
    v_mfma_f32_16x16x32_bf16 v[72:75], a[64:67], v[40:43], v[72:75]
    buffer_load_dwordx4 v[36:39], v123, s[68:71], s76 offen sc1
    v_mfma_f32_16x16x32_bf16 v[88:91], a[68:71], v[40:43], v[88:91]
    s_bfe_u32 s14, s75, 0x40008
    s_bfe_u32 s76, s75, 0x40014
    v_mfma_f32_16x16x32_bf16 a[96:99], a[72:75], v[40:43], a[96:99]
    v_lshl_add_u32 v125, s14, 6, v124
    s_mul_i32 s76, s76, 40960
    v_mfma_f32_16x16x32_bf16 a[112:115], a[76:79], v[40:43], a[112:115]
    s_mov_b64 exec, s[100:101]
    ds_write_b128 v125, v[40:43]
    s_mov_b64 exec, -1
    s_add_u32 s76, s76, s86
    s_waitcnt vmcnt(10)
    v_mfma_f32_16x16x32_bf16 v[76:79], a[64:67], v[44:47], v[76:79]
    buffer_load_dwordx4 v[40:43], v120, s[68:71], s76 offen sc1
    v_mfma_f32_16x16x32_bf16 v[92:95], a[68:71], v[44:47], v[92:95]
    ds_read_b64_tr_b16 a[48:49], v14 offset:4096
    v_mfma_f32_16x16x32_bf16 a[100:103], a[72:75], v[44:47], a[100:103]
    ds_read_b64_tr_b16 a[50:51], v14 offset:4608
    ds_read_b64_tr_b16 a[52:53], v15 offset:4096
    v_mfma_f32_16x16x32_bf16 a[116:119], a[76:79], v[44:47], a[116:119]
    ds_read_b64_tr_b16 a[54:55], v15 offset:4608
    s_waitcnt vmcnt(10)
    v_mfma_f32_16x16x32_bf16 v[80:83], a[64:67], v[48:51], v[80:83]
    buffer_load_dwordx4 v[44:47], v121, s[68:71], s76 offen sc1
    v_mfma_f32_16x16x32_bf16 v[96:99], a[68:71], v[48:51], v[96:99]
    ds_read_b64_tr_b16 a[56:57], v16 offset:4096
    ds_read_b64_tr_b16 a[58:59], v16 offset:4608
    v_mfma_f32_16x16x32_bf16 a[104:107], a[72:75], v[48:51], a[104:107]
    ds_read_b64_tr_b16 a[60:61], v17 offset:4096
    ds_read_b64_tr_b16 a[62:63], v17 offset:4608
    v_mfma_f32_16x16x32_bf16 a[120:123], a[76:79], v[48:51], a[120:123]
    s_waitcnt vmcnt(10)
    v_mfma_f32_16x16x32_bf16 v[84:87], a[64:67], v[52:55], v[84:87]
    buffer_load_dwordx4 v[48:51], v122, s[68:71], s76 offen sc1
    v_mfma_f32_16x16x32_bf16 v[100:103], a[68:71], v[52:55], v[100:103]
    v_mfma_f32_16x16x32_bf16 a[108:111], a[72:75], v[52:55], a[108:111]
    v_mfma_f32_16x16x32_bf16 a[124:127], a[76:79], v[52:55], a[124:127]
    s_waitcnt vmcnt(10)
    v_mfma_f32_16x16x32_bf16 v[72:75], a[80:83], v[56:59], v[72:75]
    buffer_load_dwordx4 v[52:55], v123, s[68:71], s76 offen sc1
    v_mfma_f32_16x16x32_bf16 v[88:91], a[84:87], v[56:59], v[88:91]
    s_bfe_u32 s14, s75, 0x4000c
    s_bfe_u32 s76, s75, 0x40018
    v_mfma_f32_16x16x32_bf16 a[96:99], a[88:91], v[56:59], a[96:99]
    v_lshl_add_u32 v125, s14, 6, v124
    s_mul_i32 s76, s76, 40960
    v_mfma_f32_16x16x32_bf16 a[112:115], a[92:95], v[56:59], a[112:115]
    s_mov_b64 exec, s[100:101]
    ds_write_b128 v125, v[56:59]
    s_mov_b64 exec, -1
    s_add_u32 s76, s76, s86
    s_waitcnt vmcnt(10)
    v_mfma_f32_16x16x32_bf16 v[76:79], a[80:83], v[60:63], v[76:79]
    buffer_load_dwordx4 v[56:59], v120, s[68:71], s76 offen sc1
    v_mfma_f32_16x16x32_bf16 v[92:95], a[84:87], v[60:63], v[92:95]
    v_mov_b32 v20, 1
    v_mfma_f32_16x16x32_bf16 a[100:103], a[88:91], v[60:63], a[100:103]
    s_mov_b64 exec, 1
    ds_add_u32 v0, v20 offset:56
    s_mov_b64 exec, -1
    v_mfma_f32_16x16x32_bf16 a[116:119], a[92:95], v[60:63], a[116:119]
    s_waitcnt vmcnt(10)
    v_mfma_f32_16x16x32_bf16 v[80:83], a[80:83], v[64:67], v[80:83]
    buffer_load_dwordx4 v[60:63], v121, s[68:71], s76 offen sc1
    v_mfma_f32_16x16x32_bf16 v[96:99], a[84:87], v[64:67], v[96:99]
    v_mfma_f32_16x16x32_bf16 a[104:107], a[88:91], v[64:67], a[104:107]
    v_mfma_f32_16x16x32_bf16 a[120:123], a[92:95], v[64:67], a[120:123]
    s_waitcnt vmcnt(10)
    v_mfma_f32_16x16x32_bf16 v[84:87], a[80:83], v[68:71], v[84:87]
    buffer_load_dwordx4 v[64:67], v122, s[68:71], s76 offen sc1
    v_mfma_f32_16x16x32_bf16 v[100:103], a[84:87], v[68:71], v[100:103]
    v_mfma_f32_16x16x32_bf16 a[108:111], a[88:91], v[68:71], a[108:111]
    v_mfma_f32_16x16x32_bf16 a[124:127], a[92:95], v[68:71], a[124:127]
    s_waitcnt lgkmcnt(15)
    s_waitcnt vmcnt(10)
    v_mfma_f32_16x16x32_bf16 v[72:75], a[0:3], v[24:27], v[72:75]
    buffer_load_dwordx4 v[68:71], v123, s[68:71], s76 offen sc1
    v_mfma_f32_16x16x32_bf16 v[88:91], a[4:7], v[24:27], v[88:91]
    s_bfe_u32 s14, s75, 0x40010
    s_bfe_u32 s76, s75, 0x4001c
    v_mfma_f32_16x16x32_bf16 a[96:99], a[8:11], v[24:27], a[96:99]
    v_lshl_add_u32 v125, s14, 6, v124
    s_mul_i32 s76, s76, 40960
    v_mfma_f32_16x16x32_bf16 a[112:115], a[12:15], v[24:27], a[112:115]
    s_mov_b64 exec, s[100:101]
    ds_write_b128 v125, v[24:27]
    s_mov_b64 exec, -1
    s_add_u32 s76, s76, s86
    s_waitcnt vmcnt(10)
    v_mfma_f32_16x16x32_bf16 v[76:79], a[0:3], v[28:31], v[76:79]
    buffer_load_dwordx4 v[24:27], v120, s[68:71], s76 offen sc1
    v_mfma_f32_16x16x32_bf16 v[92:95], a[4:7], v[28:31], v[92:95]
    v_mfma_f32_16x16x32_bf16 a[100:103], a[8:11], v[28:31], a[100:103]
    v_mfma_f32_16x16x32_bf16 a[116:119], a[12:15], v[28:31], a[116:119]
    s_waitcnt vmcnt(10)
    v_mfma_f32_16x16x32_bf16 v[80:83], a[0:3], v[32:35], v[80:83]
    buffer_load_dwordx4 v[28:31], v121, s[68:71], s76 offen sc1
    v_mfma_f32_16x16x32_bf16 v[96:99], a[4:7], v[32:35], v[96:99]
    v_mfma_f32_16x16x32_bf16 a[104:107], a[8:11], v[32:35], a[104:107]
    v_mfma_f32_16x16x32_bf16 a[120:123], a[12:15], v[32:35], a[120:123]
    s_waitcnt vmcnt(10)
    v_mfma_f32_16x16x32_bf16 v[84:87], a[0:3], v[36:39], v[84:87]
    buffer_load_dwordx4 v[32:35], v122, s[68:71], s76 offen sc1
    v_mfma_f32_16x16x32_bf16 v[100:103], a[4:7], v[36:39], v[100:103]
    v_mfma_f32_16x16x32_bf16 a[108:111], a[8:11], v[36:39], a[108:111]
    v_mfma_f32_16x16x32_bf16 a[124:127], a[12:15], v[36:39], a[124:127]
    s_waitcnt vmcnt(10)
    v_mfma_f32_16x16x32_bf16 v[72:75], a[16:19], v[40:43], v[72:75]
    buffer_load_dwordx4 v[36:39], v123, s[68:71], s76 offen sc1
    v_mfma_f32_16x16x32_bf16 v[88:91], a[20:23], v[40:43], v[88:91]
    s_bfe_u32 s14, s75, 0x40014
    v_mfma_f32_16x16x32_bf16 a[96:99], a[24:27], v[40:43], a[96:99]
    v_lshl_add_u32 v125, s14, 6, v124
    v_mfma_f32_16x16x32_bf16 a[112:115], a[28:31], v[40:43], a[112:115]
    s_mov_b64 exec, s[100:101]
    ds_write_b128 v125, v[40:43]
    s_mov_b64 exec, -1
    s_waitcnt vmcnt(10)
    v_mov_b32 v20, 1
    v_mfma_f32_16x16x32_bf16 v[92:95], a[20:23], v[44:47], v[92:95]
    s_mov_b64 exec, 1
    ds_add_u32 v0, v20 offset:72
    s_mov_b64 exec, -1
    v_mfma_f32_16x16x32_bf16 a[100:103], a[24:27], v[44:47], a[100:103]
    v_mfma_f32_16x16x32_bf16 a[116:119], a[28:31], v[44:47], a[116:119]
    s_waitcnt vmcnt(9)
    v_mfma_f32_16x16x32_bf16 v[96:99], a[20:23], v[48:51], v[96:99]
    v_mfma_f32_16x16x32_bf16 a[104:107], a[24:27], v[48:51], a[104:107]
    v_mfma_f32_16x16x32_bf16 a[120:123], a[28:31], v[48:51], a[120:123]
    s_waitcnt vmcnt(8)
    v_mfma_f32_16x16x32_bf16 v[100:103], a[20:23], v[52:55], v[100:103]
    v_mfma_f32_16x16x32_bf16 a[108:111], a[24:27], v[52:55], a[108:111]
    v_mfma_f32_16x16x32_bf16 a[124:127], a[28:31], v[52:55], a[124:127]
    s_waitcnt lgkmcnt(14)
    s_waitcnt vmcnt(7)
    v_mfma_f32_16x16x32_bf16 v[88:91], a[36:39], v[56:59], v[88:91]
    s_bfe_u32 s14, s75, 0x40018
    v_mfma_f32_16x16x32_bf16 a[96:99], a[40:43], v[56:59], a[96:99]
    v_lshl_add_u32 v125, s14, 6, v124
    v_mfma_f32_16x16x32_bf16 a[112:115], a[44:47], v[56:59], a[112:115]
    s_mov_b64 exec, s[100:101]
    ds_write_b128 v125, v[56:59]
    s_mov_b64 exec, -1
    s_waitcnt vmcnt(6)
    v_mfma_f32_16x16x32_bf16 v[92:95], a[36:39], v[60:63], v[92:95]
    v_mfma_f32_16x16x32_bf16 a[100:103], a[40:43], v[60:63], a[100:103]
    v_mfma_f32_16x16x32_bf16 a[116:119], a[44:47], v[60:63], a[116:119]
    s_waitcnt vmcnt(5)
    v_mfma_f32_16x16x32_bf16 v[96:99], a[36:39], v[64:67], v[96:99]
    v_mfma_f32_16x16x32_bf16 a[104:107], a[40:43], v[64:67], a[104:107]
    v_mfma_f32_16x16x32_bf16 a[120:123], a[44:47], v[64:67], a[120:123]
    s_waitcnt vmcnt(4)
    v_mfma_f32_16x16x32_bf16 v[100:103], a[36:39], v[68:71], v[100:103]
    v_mfma_f32_16x16x32_bf16 a[108:111], a[40:43], v[68:71], a[108:111]
    v_mfma_f32_16x16x32_bf16 a[124:127], a[44:47], v[68:71], a[124:127]
    v_add_u32 v21, s73, v2
    s_waitcnt lgkmcnt(6)
    s_waitcnt vmcnt(3)
    v_mfma_f32_16x16x32_bf16 v[88:91], a[52:55], v[24:27], v[88:91]
    s_bfe_u32 s14, s75, 0x4001c
    v_mfma_f32_16x16x32_bf16 a[96:99], a[56:59], v[24:27], a[96:99]
    v_lshl_add_u32 v125, s14, 6, v124
    v_mfma_f32_16x16x32_bf16 a[112:115], a[60:63], v[24:27], a[112:115]
    s_mov_b64 exec, s[100:101]
    ds_write_b128 v125, v[24:27]
    s_mov_b64 exec, -1
    s_waitcnt vmcnt(2)
    v_mov_b32 v20, 1
    v_mfma_f32_16x16x32_bf16 v[92:95], a[52:55], v[28:31], v[92:95]
    s_mov_b64 exec, 1
    ds_add_u32 v0, v20 offset:60
    s_mov_b64 exec, -1
    v_mfma_f32_16x16x32_bf16 a[100:103], a[56:59], v[28:31], a[100:103]
    ds_read_b32 v22, v0 offset:72
    v_mfma_f32_16x16x32_bf16 a[116:119], a[60:63], v[28:31], a[116:119]
    s_waitcnt vmcnt(1)
    v_mfma_f32_16x16x32_bf16 v[96:99], a[52:55], v[32:35], v[96:99]
    v_mfma_f32_16x16x32_bf16 a[104:107], a[56:59], v[32:35], a[104:107]
    v_mfma_f32_16x16x32_bf16 a[120:123], a[60:63], v[32:35], a[120:123]
    s_waitcnt vmcnt(0)
    v_mfma_f32_16x16x32_bf16 v[100:103], a[52:55], v[36:39], v[100:103]
    v_mfma_f32_16x16x32_bf16 a[108:111], a[56:59], v[36:39], a[108:111]
    v_mfma_f32_16x16x32_bf16 a[124:127], a[60:63], v[36:39], a[124:127]
    s_waitcnt lgkmcnt(0)
    v_readfirstlane_b32 s87, v22
    s_nop 0
    s_cmp_lt_u32 s87, 4
    s_cbranch_scc1 L_eb1
    s_bfe_u32 s72, s80, 0x40000
    s_mul_i32 s72, s72, 131072
    s_add_u32 s72, s72, s92
    s_add_u32 m0, s73, 12288
    s_nop 0
    buffer_load_dwordx4 v12, s[60:63], s72 offen  lds
    s_add_u32 s72, s72, 32768
    s_add_u32 m0, s73, 13312
    s_nop 0
    buffer_load_dwordx4 v13, s[60:63], s72 offen  lds
    s_add_u32 s72, s72, 32768
    s_add_u32 m0, s73, 14336
    s_nop 0
    buffer_load_dwordx4 v12, s[60:63], s72 offen  lds
    s_add_u32 s72, s72, 32768
    s_add_u32 m0, s73, 15360
    s_nop 0
    buffer_load_dwordx4 v13, s[60:63], s72 offen  lds
    s_bfe_u32 s72, s80, 0x40004
    s_mul_i32 s72, s72, 131072
    s_add_u32 s72, s72, s92
    s_add_u32 m0, s73, 16384
    s_nop 0
    buffer_load_dwordx4 v12, s[60:63], s72 offen  lds
    s_add_u32 s72, s72, 32768
    s_add_u32 m0, s73, 17408
    s_nop 0
    buffer_load_dwordx4 v13, s[60:63], s72 offen  lds
    s_add_u32 s72, s72, 32768
    s_add_u32 m0, s73, 18432
    s_nop 0
    buffer_load_dwordx4 v12, s[60:63], s72 offen  lds
    s_add_u32 s72, s72, 32768
    s_add_u32 m0, s73, 19456
    s_nop 0
    buffer_load_dwordx4 v13, s[60:63], s72 offen  lds
L_eb1:
    v_mfma_f32_16x16x32_bf16 v[76:79], a[16:19], v[44:47], v[76:79]
    ds_write_b128 v21, v[88:91] offset:0
    v_mfma_f32_16x16x32_bf16 v[80:83], a[16:19], v[48:51], v[80:83]
    ds_write_b128 v21, a[96:99] offset:4096
    v_mfma_f32_16x16x32_bf16 v[84:87], a[16:19], v[52:55], v[84:87]
    ds_write_b128 v21, a[112:115] offset:8192
    v_mfma_f32_16x16x32_bf16 v[72:75], a[32:35], v[56:59], v[72:75]
    ds_write_b128 v21, v[92:95] offset:1024
    v_mfma_f32_16x16x32_bf16 v[76:79], a[32:35], v[60:63], v[76:79]
    ds_write_b128 v21, a[100:103] offset:5120
    v_mfma_f32_16x16x32_bf16 v[80:83], a[32:35], v[64:67], v[80:83]
    ds_write_b128 v21, a[116:119] offset:9216
    v_mfma_f32_16x16x32_bf16 v[84:87], a[32:35], v[68:71], v[84:87]
    ds_write_b128 v21, v[96:99] offset:2048
    v_mfma_f32_16x16x32_bf16 v[72:75], a[48:51], v[24:27], v[72:75]
    ds_write_b128 v21, a[104:107] offset:6144
    v_mfma_f32_16x16x32_bf16 v[76:79], a[48:51], v[28:31], v[76:79]
    ds_write_b128 v21, a[120:123] offset:10240
    v_mfma_f32_16x16x32_bf16 v[80:83], a[48:51], v[32:35], v[80:83]
    ds_write_b128 v21, v[100:103] offset:3072
    v_mfma_f32_16x16x32_bf16 v[84:87], a[48:51], v[36:39], v[84:87]
    ds_write_b128 v21, a[108:111] offset:7168
    ds_write_b128 v21, a[124:127] offset:11264
    v_mov_b32 v20, 1
    s_mov_b64 exec, 1
    ds_add_u32 v0, v20 offset:8
    s_mov_b64 exec, -1
    s_cmp_ge_u32 s87, 4
    s_cbranch_scc1 L_eb2
    s_mov_b32 s78, 0
    s_branch Lspinf_20
Lspin_18:
    s_sleep 1
Lspinf_20:
    ds_read_b32 v22, v0 offset:72
    s_add_u32 s78, s78, 1
    s_waitcnt lgkmcnt(0)
    v_readfirstlane_b32 s79, v22
    s_cmp_gt_u32 s78, 0x200000
    s_cbranch_scc1 Lspind_19
    s_cmp_lt_u32 s79, 4
    s_cbranch_scc1 Lspin_18
Lspind_19:
    s_bfe_u32 s72, s80, 0x40000
    s_mul_i32 s72, s72, 131072
    s_add_u32 s72, s72, s92
    s_add_u32 m0, s73, 12288
    s_nop 0
    buffer_load_dwordx4 v12, s[60:63], s72 offen  lds
    s_add_u32 s72, s72, 32768
    s_add_u32 m0, s73, 13312
    s_nop 0
    buffer_load_dwordx4 v13, s[60:63], s72 offen  lds
    s_add_u32 s72, s72, 32768
    s_add_u32 m0, s73, 14336
    s_nop 0
    buffer_load_dwordx4 v12, s[60:63], s72 offen  lds
    s_add_u32 s72, s72, 32768
    s_add_u32 m0, s73, 15360
    s_nop 0
    buffer_load_dwordx4 v13, s[60:63], s72 offen  lds
    s_bfe_u32 s72, s80, 0x40004
    s_mul_i32 s72, s72, 131072
    s_add_u32 s72, s72, s92
    s_add_u32 m0, s73, 16384
    s_nop 0
    buffer_load_dwordx4 v12, s[60:63], s72 offen  lds
    s_add_u32 s72, s72, 32768
    s_add_u32 m0, s73, 17408
    s_nop 0
    buffer_load_dwordx4 v13, s[60:63], s72 offen  lds
    s_add_u32 s72, s72, 32768
    s_add_u32 m0, s73, 18432
    s_nop 0
    buffer_load_dwordx4 v12, s[60:63], s72 offen  lds
    s_add_u32 s72, s72, 32768
    s_add_u32 m0, s73, 19456
    s_nop 0
    buffer_load_dwordx4 v13, s[60:63], s72 offen  lds
L_eb2:
    s_xor_b32 s51, s3, 1
    s_mul_i32 s51, s51, 28672
    s_add_u32 s51, s51, 45056
    v_add_u32 v21, s51, v2
    s_xor_b32 s51, s3, 2
    s_mul_i32 s51, s51, 28672
    s_add_u32 s51, s51, 49152
    v_add_u32 v22, s51, v2
    s_xor_b32 s51, s3, 3
    s_mul_i32 s51, s51, 28672
    s_add_u32 s51, s51, 53248
    v_add_u32 v23, s51, v2
    s_lshl_b32 s50, s7, 3
    s_lshl_b32 s51, s3, 1
    s_add_u32 s50, s50, s51
    s_mul_i32 s50, s50, 10240
    s_lshl_b32 s51, s6, 10
    s_add_u32 s50, s50, s51
    s_add_u32 s86, s50, 3145728
    s_mul_i32 s89, s6, 24
    s_add_u32 s89, s89, s7
    s_lshl_b32 s89, s89, 7
    s_add_u32 s89, s89, 327680
    s_mov_b32 s90, 0xbdd2d3e8
    v_mov_b32 v126, 0xc0135761
    s_mov_b32 s78, 0
Lspin_21:
    ds_read_b32 v20, v0 offset:8
    s_add_u32 s78, s78, 1
    s_waitcnt lgkmcnt(0)
    v_readfirstlane_b32 s79, v20
    s_cmp_gt_u32 s78, 0x200000
    s_cbranch_scc1 Lspind_22
    s_cmp_lt_u32 s79, 4
    s_cbranch_scc1 Lspin_21
Lspind_22:
    ds_read_b128 v[24:27], v21 offset:0
    ds_read_b128 v[40:43], v22 offset:0
    ds_read_b128 v[56:59], v23 offset:0
    ds_read_b128 v[28:31], v21 offset:1024
    ds_read_b128 v[44:47], v22 offset:1024
    ds_read_b128 v[60:63], v23 offset:1024
    ds_read_b128 v[32:35], v21 offset:2048
    ds_read_b128 v[48:51], v22 offset:2048
    ds_read_b128 v[64:67], v23 offset:2048
    ds_read_b128 v[36:39], v21 offset:3072
    ds_read_b128 v[52:55], v22 offset:3072
    ds_read_b128 v[68:71], v23 offset:3072
    s_waitcnt lgkmcnt(6)
    v_pk_add_f32 v[72:73], v[72:73], v[24:25]
    v_pk_add_f32 v[40:41], v[40:41], v[56:57]
    v_pk_add_f32 v[74:75], v[74:75], v[26:27]
    v_pk_add_f32 v[42:43], v[42:43], v[58:59]
    v_pk_add_f32 v[76:77], v[76:77], v[28:29]
    v_pk_add_f32 v[44:45], v[44:45], v[60:61]
    v_pk_add_f32 v[78:79], v[78:79], v[30:31]
    v_pk_add_f32 v[46:47], v[46:47], v[62:63]
    v_pk_add_f32 v[72:73], v[72:73], v[40:41]
    v_pk_add_f32 v[74:75], v[74:75], v[42:43]
    v_pk_add_f32 v[76:77], v[76:77], v[44:45]
    v_pk_add_f32 v[78:79], v[78:79], v[46:47]
    v_pk_mul_f32 v[88:89], v[72:73], v[72:73]
    v_pk_mul_f32 v[90:91], v[74:75], v[74:75]
    v_pk_mul_f32 v[92:93], v[76:77], v[76:77]
    v_pk_mul_f32 v[94:95], v[78:79], v[78:79]
    v_pk_fma_f32 v[88:89], v[88:89], s[90:91], v[126:127] op_sel_hi:[1,0,0]
    v_pk_fma_f32 v[90:91], v[90:91], s[90:91], v[126:127] op_sel_hi:[1,0,0]
    v_pk_fma_f32 v[92:93], v[92:93], s[90:91], v[126:127] op_sel_hi:[1,0,0]
    v_pk_fma_f32 v[94:95], v[94:95], s[90:91], v[126:127] op_sel_hi:[1,0,0]
    v_pk_mul_f32 v[88:89], v[88:89], v[72:73]
    v_pk_mul_f32 v[90:91], v[90:91], v[74:75]
    v_pk_mul_f32 v[92:93], v[92:93], v[76:77]
    v_pk_mul_f32 v[94:95], v[94:95], v[78:79]
    v_exp_f32 v88, v88
    v_exp_f32 v89, v89
    v_exp_f32 v90, v90
    v_exp_f32 v91, v91
    v_exp_f32 v92, v92
    v_exp_f32 v93, v93
    v_exp_f32 v94, v94
    v_exp_f32 v95, v95
    v_pk_add_f32 v[88:89], v[88:89], 1.0 op_sel_hi:[1,0]
    v_pk_add_f32 v[90:91], v[90:91], 1.0 op_sel_hi:[1,0]
    v_pk_add_f32 v[92:93], v[92:93], 1.0 op_sel_hi:[1,0]
    v_pk_add_f32 v[94:95], v[94:95], 1.0 op_sel_hi:[1,0]
    v_rcp_f32 v88, v88
    v_rcp_f32 v89, v89
    v_rcp_f32 v90, v90
    v_rcp_f32 v91, v91
    v_rcp_f32 v92, v92
    v_rcp_f32 v93, v93
    v_rcp_f32 v94, v94
    v_rcp_f32 v95, v95
    v_pk_mul_f32 v[88:89], v[88:89], v[72:73]
    v_pk_mul_f32 v[90:91], v[90:91], v[74:75]
    v_pk_mul_f32 v[92:93], v[92:93], v[76:77]
    v_pk_mul_f32 v[94:95], v[94:95], v[78:79]
    v_cvt_pk_bf16_f32 v56, v88, v89
    v_cvt_pk_bf16_f32 v57, v90, v91
    v_cvt_pk_bf16_f32 v58, v92, v93
    v_cvt_pk_bf16_f32 v59, v94, v95
    s_nop 0
    v_permlane16_swap_b32 v56, v58
    v_permlane16_swap_b32 v57, v59
    buffer_store_dwordx4 v[56:59], v6, s[68:71], s86 offen sc1
    s_waitcnt lgkmcnt(0)
    v_pk_add_f32 v[80:81], v[80:81], v[32:33]
    v_pk_add_f32 v[48:49], v[48:49], v[64:65]
    v_pk_add_f32 v[82:83], v[82:83], v[34:35]
    v_pk_add_f32 v[50:51], v[50:51], v[66:67]
    v_pk_add_f32 v[84:85], v[84:85], v[36:37]
    v_pk_add_f32 v[52:53], v[52:53], v[68:69]
    v_pk_add_f32 v[86:87], v[86:87], v[38:39]
    v_pk_add_f32 v[54:55], v[54:55], v[70:71]
    v_pk_add_f32 v[80:81], v[80:81], v[48:49]
    v_pk_add_f32 v[82:83], v[82:83], v[50:51]
    v_pk_add_f32 v[84:85], v[84:85], v[52:53]
    v_pk_add_f32 v[86:87], v[86:87], v[54:55]
    v_pk_mul_f32 v[96:97], v[80:81], v[80:81]
    v_pk_mul_f32 v[98:99], v[82:83], v[82:83]
    v_pk_mul_f32 v[100:101], v[84:85], v[84:85]
    v_pk_mul_f32 v[102:103], v[86:87], v[86:87]
    v_pk_fma_f32 v[96:97], v[96:97], s[90:91], v[126:127] op_sel_hi:[1,0,0]
    v_pk_fma_f32 v[98:99], v[98:99], s[90:91], v[126:127] op_sel_hi:[1,0,0]
    v_pk_fma_f32 v[100:101], v[100:101], s[90:91], v[126:127] op_sel_hi:[1,0,0]
    v_pk_fma_f32 v[102:103], v[102:103], s[90:91], v[126:127] op_sel_hi:[1,0,0]
    v_pk_mul_f32 v[96:97], v[96:97], v[80:81]
    v_pk_mul_f32 v[98:99], v[98:99], v[82:83]
    v_pk_mul_f32 v[100:101], v[100:101], v[84:85]
    v_pk_mul_f32 v[102:103], v[102:103], v[86:87]
    v_exp_f32 v96, v96
    v_exp_f32 v97, v97
    v_exp_f32 v98, v98
    v_exp_f32 v99, v99
    v_exp_f32 v100, v100
    v_exp_f32 v101, v101
    v_exp_f32 v102, v102
    v_exp_f32 v103, v103
    v_pk_add_f32 v[96:97], v[96:97], 1.0 op_sel_hi:[1,0]
    v_pk_add_f32 v[98:99], v[98:99], 1.0 op_sel_hi:[1,0]
    v_pk_add_f32 v[100:101], v[100:101], 1.0 op_sel_hi:[1,0]
    v_pk_add_f32 v[102:103], v[102:103], 1.0 op_sel_hi:[1,0]
    v_rcp_f32 v96, v96
    v_rcp_f32 v97, v97
    v_rcp_f32 v98, v98
    v_rcp_f32 v99, v99
    v_rcp_f32 v100, v100
    v_rcp_f32 v101, v101
    v_rcp_f32 v102, v102
    v_rcp_f32 v103, v103
    v_pk_mul_f32 v[96:97], v[96:97], v[80:81]
    v_pk_mul_f32 v[98:99], v[98:99], v[82:83]
    v_pk_mul_f32 v[100:101], v[100:101], v[84:85]
    v_pk_mul_f32 v[102:103], v[102:103], v[86:87]
    v_cvt_pk_bf16_f32 v64, v96, v97
    v_cvt_pk_bf16_f32 v65, v98, v99
    v_cvt_pk_bf16_f32 v66, v100, v101
    v_cvt_pk_bf16_f32 v67, v102, v103
    s_nop 0
    v_permlane16_swap_b32 v64, v66
    v_permlane16_swap_b32 v65, v67
    buffer_store_dwordx4 v[64:67], v7, s[68:71], s86 offen sc1
    v_mov_b32 v20, 1
    s_mov_b64 exec, 1
    ds_add_u32 v0, v20 offset:12
    s_mov_b64 exec, -1
    v_lshlrev_b32 v114, 16, v114
    v_mov_b32 v84, v114
    v_mov_b32 v85, v114
    v_mov_b32 v86, v114
    v_mov_b32 v87, v114
    v_mov_b32 v88, v114
    v_mov_b32 v89, v114
    v_mov_b32 v90, v114
    v_mov_b32 v91, v114
    v_mov_b32 v92, v114
    v_mov_b32 v93, v114
    v_mov_b32 v94, v114
    v_mov_b32 v95, v114
    v_mov_b32 v96, v114
    v_mov_b32 v97, v114
    v_mov_b32 v98, v114
    v_mov_b32 v99, v114
    v_mov_b32 v100, v114
    v_mov_b32 v101, v114
    v_mov_b32 v102, v114
    v_mov_b32 v103, v114
    v_lshrrev_b32 v22, 4, v1
    v_and_b32 v23, 15, v1
    v_lshlrev_b32 v24, 3, v22
    v_sub_u32 v24, v23, v24
    v_and_b32 v25, 1, v24
    v_lshlrev_b32 v25, 4, v25
    v_mov_b32 v26, 0x3f80
    v_lshlrev_b32 v25, v25, v26
    v_ashrrev_i32 v24, 1, v24
    v_cmp_eq_u32 vcc, 0, v24
    s_nop 1
    v_cndmask_b32 v120, 0, v25, vcc
    v_cmp_eq_u32 vcc, 1, v24
    s_nop 1
    v_cndmask_b32 v121, 0, v25, vcc
    v_cmp_eq_u32 vcc, 2, v24
    s_nop 1
    v_cndmask_b32 v122, 0, v25, vcc
    v_cmp_eq_u32 vcc, 3, v24
    s_nop 1
    v_cndmask_b32 v123, 0, v25, vcc
    v_cmp_eq_i32 vcc, -8, v24
    s_nop 1
    v_cndmask_b32 v124, 0, v25, vcc
    v_cmp_eq_i32 vcc, -7, v24
    s_nop 1
    v_cndmask_b32 v125, 0, v25, vcc
    v_cmp_eq_i32 vcc, -6, v24
    s_nop 1
    v_cndmask_b32 v126, 0, v25, vcc
    v_cmp_eq_i32 vcc, -5, v24
    s_nop 1
    v_cndmask_b32 v127, 0, v25, vcc
    v_mfma_f32_16x16x32_bf16 v[84:87], v[120:123], v[104:107], v[84:87]
    s_nop 0
    v_mfma_f32_16x16x32_bf16 v[88:91], v[124:127], v[104:107], v[88:91]
    v_mfma_f32_16x16x32_bf16 v[92:95], v[120:123], v[110:113], v[92:95]
    v_mfma_f32_16x16x32_bf16 v[96:99], v[124:127], v[110:113], v[96:99]
    v_mfma_f32_16x16x32_bf16 v[100:103], v[120:123], v[116:119], v[100:103]
    s_and_b32 s51, s3, 1
    s_cmp_eq_u32 s51, 0
    s_cbranch_scc1 Lnsw_24
    v_swap_b32 v120, v124
    v_swap_b32 v121, v125
    v_swap_b32 v122, v126
    v_swap_b32 v123, v127
Lnsw_24:
    s_waitcnt vmcnt(6)
    ds_read_b64_tr_b16 a[0:1], v14 offset:12288
    ds_read_b64_tr_b16 a[2:3], v14 offset:12800
    ds_read_b64_tr_b16 a[4:5], v15 offset:12288
    ds_read_b64_tr_b16 a[6:7], v15 offset:12800
    ds_read_b64_tr_b16 a[8:9], v16 offset:12288
    ds_read_b64_tr_b16 a[10:11], v16 offset:12800
    ds_read_b64_tr_b16 a[12:13], v17 offset:12288
    ds_read_b64_tr_b16 a[14:15], v17 offset:12800
    s_waitcnt vmcnt(2)
    ds_read_b64_tr_b16 a[16:17], v14 offset:16384
    ds_read_b64_tr_b16 a[18:19], v14 offset:16896
    ds_read_b64_tr_b16 a[20:21], v15 offset:16384
    ds_read_b64_tr_b16 a[22:23], v15 offset:16896
    ds_read_b64_tr_b16 a[24:25], v16 offset:16384
    ds_read_b64_tr_b16 a[26:27], v16 offset:16896
    ds_read_b64_tr_b16 a[28:29], v17 offset:16384
    ds_read_b64_tr_b16 a[30:31], v17 offset:16896
    s_waitcnt vmcnt(0)
    v_mov_b32 v20, 1
    s_mov_b64 exec, 1
    ds_add_rtn_u32 v20, v0, v20 offset:24
    s_mov_b64 exec, -1
    s_waitcnt lgkmcnt(0)
    v_readfirstlane_b32 s79, v20
    s_nop 0
    s_cmp_lg_u32 s79, 3
    s_cbranch_scc1 Lnolast_25
    s_mov_b64 exec, 1
    buffer_store_dword v9, v10, s[68:71], s89 offen sc1
    s_mov_b64 exec, -1
Lnolast_25:
L_g2:
    s_mul_i32 s86, s3, 491520
    s_mul_i32 s51, s8, 1280
    s_add_u32 s86, s86, s51
    s_add_u32 s86, s86, 3145728
    s_mul_i32 s88, s8, 327680
    s_and_b32 s51, s95, 0xffffffc0
    s_add_u32 s88, s88, s51
    s_add_u32 s88, s88, 5111808
    v_and_b32 v116, 15, v1
    v_mul_u32_u24 v116, 1280, v116
    v_and_b32 v117, 16, v1
    v_lshl_add_u32 v116, v117, 1, v116
    v_lshrrev_b32 v117, 5, v1
    v_lshl_add_u32 v116, v117, 4, v116
    s_and_b32 s51, s3, 1
    s_lshl_b32 s51, s51, 26
    v_add_u32 v109, s51, v115
    v_xor_b32 v115, 0x4000000, v109
    s_mov_b32 s78, 0
Lspin_26:
    ds_read_b32 v20, v0 offset:24
    s_add_u32 s78, s78, 1
    s_waitcnt lgkmcnt(0)
    v_readfirstlane_b32 s79, v20
    s_cmp_gt_u32 s78, 0x200000
    s_cbranch_scc1 Lspind_27
    s_cmp_lt_u32 s79, 4
    s_cbranch_scc1 Lspin_26
Lspind_27:
    s_bfe_u32 s72, s80, 0x40008
    s_mul_i32 s72, s72, 131072
    s_add_u32 s72, s72, s92
    s_add_u32 m0, s73, 20480
    s_nop 0
    buffer_load_dwordx4 v12, s[60:63], s72 offen  lds
    s_add_u32 s72, s72, 32768
    s_add_u32 m0, s73, 21504
    s_nop 0
    buffer_load_dwordx4 v13, s[60:63], s72 offen  lds
    s_add_u32 s72, s72, 32768
    s_add_u32 m0, s73, 22528
    s_nop 0
    buffer_load_dwordx4 v12, s[60:63], s72 offen  lds
    s_add_u32 s72, s72, 32768
    s_add_u32 m0, s73, 23552
    s_nop 0
    buffer_load_dwordx4 v13, s[60:63], s72 offen  lds
    s_bfe_u32 s72, s80, 0x4000c
    s_mul_i32 s72, s72, 131072
    s_add_u32 s72, s72, s92
    s_add_u32 m0, s73, 24576
    s_nop 0
    buffer_load_dwordx4 v12, s[60:63], s72 offen  lds
    s_add_u32 s72, s72, 32768
    s_add_u32 m0, s73, 25600
    s_nop 0
    buffer_load_dwordx4 v13, s[60:63], s72 offen  lds
    s_add_u32 s72, s72, 32768
    s_add_u32 m0, s73, 26624
    s_nop 0
    buffer_load_dwordx4 v12, s[60:63], s72 offen  lds
    s_add_u32 s72, s72, 32768
    s_add_u32 m0, s73, 27648
    s_nop 0
    buffer_load_dwordx4 v13, s[60:63], s72 offen  lds
    s_bfe_u32 s72, s80, 0x40010
    s_mul_i32 s72, s72, 131072
    s_add_u32 s72, s72, s92
    s_add_u32 m0, s73, 0
    s_nop 0
    buffer_load_dwordx4 v12, s[60:63], s72 offen  lds
    s_add_u32 s72, s72, 32768
    s_add_u32 m0, s73, 1024
    s_nop 0
    buffer_load_dwordx4 v13, s[60:63], s72 offen  lds
    s_add_u32 s72, s72, 32768
    s_add_u32 m0, s73, 2048
    s_nop 0
    buffer_load_dwordx4 v12, s[60:63], s72 offen  lds
    s_add_u32 s72, s72, 32768
    s_add_u32 m0, s73, 3072
    s_nop 0
    buffer_load_dwordx4 v13, s[60:63], s72 offen  lds
    s_bfe_u32 s72, s80, 0x40014
    s_mul_i32 s72, s72, 131072
    s_add_u32 s72, s72, s92
    s_add_u32 m0, s73, 4096
    s_nop 0
    buffer_load_dwordx4 v12, s[60:63], s72 offen  lds
    s_add_u32 s72, s72, 32768
    s_add_u32 m0, s73, 5120
    s_nop 0
    buffer_load_dwordx4 v13, s[60:63], s72 offen  lds
    s_add_u32 s72, s72, 32768
    s_add_u32 m0, s73, 6144
    s_nop 0
    buffer_load_dwordx4 v12, s[60:63], s72 offen  lds
    s_add_u32 s72, s72, 32768
    s_add_u32 m0, s73, 7168
    s_nop 0
    buffer_load_dwordx4 v13, s[60:63], s72 offen  lds
    s_waitcnt vmcnt(12)
    ds_read_b64_tr_b16 a[32:33], v14 offset:20480
    ds_read_b64_tr_b16 a[34:35], v14 offset:20992
    ds_read_b64_tr_b16 a[36:37], v15 offset:20480
    ds_read_b64_tr_b16 a[38:39], v15 offset:20992
    ds_read_b64_tr_b16 a[40:41], v16 offset:20480
    ds_read_b64_tr_b16 a[42:43], v16 offset:20992
    ds_read_b64_tr_b16 a[44:45], v17 offset:20480
    ds_read_b64_tr_b16 a[46:47], v17 offset:20992
    s_bfe_u32 s72, s80, 0x40018
    s_mul_i32 s72, s72, 131072
    s_add_u32 s72, s72, s92
    s_add_u32 m0, s73, 8192
    s_nop 0
    buffer_load_dwordx4 v12, s[60:63], s72 offen  lds
    s_add_u32 s72, s72, 32768
    s_add_u32 m0, s73, 9216
    s_nop 0
    buffer_load_dwordx4 v13, s[60:63], s72 offen  lds
    s_add_u32 s72, s72, 32768
    s_add_u32 m0, s73, 10240
    s_nop 0
    buffer_load_dwordx4 v12, s[60:63], s72 offen  lds
    s_add_u32 s72, s72, 32768
    s_add_u32 m0, s73, 11264
    s_nop 0
    buffer_load_dwordx4 v13, s[60:63], s72 offen  lds
    s_waitcnt vmcnt(12)
    ds_read_b64_tr_b16 a[48:49], v14 offset:24576
    ds_read_b64_tr_b16 a[50:51], v14 offset:25088
    ds_read_b64_tr_b16 a[52:53], v15 offset:24576
    ds_read_b64_tr_b16 a[54:55], v15 offset:25088
    ds_read_b64_tr_b16 a[56:57], v16 offset:24576
    ds_read_b64_tr_b16 a[58:59], v16 offset:25088
    ds_read_b64_tr_b16 a[60:61], v17 offset:24576
    ds_read_b64_tr_b16 a[62:63], v17 offset:25088
    s_bfe_u32 s72, s80, 0x4001c
    s_mul_i32 s72, s72, 131072
    s_add_u32 s72, s72, s92
    s_add_u32 m0, s73, 12288
    s_nop 0
    buffer_load_dwordx4 v12, s[60:63], s72 offen  lds
    s_add_u32 s72, s72, 32768
    s_add_u32 m0, s73, 13312
    s_nop 0
    buffer_load_dwordx4 v13, s[60:63], s72 offen  lds
    s_add_u32 s72, s72, 32768
    s_add_u32 m0, s73, 14336
    s_nop 0
    buffer_load_dwordx4 v12, s[60:63], s72 offen  lds
    s_add_u32 s72, s72, 32768
    s_add_u32 m0, s73, 15360
    s_nop 0
    buffer_load_dwordx4 v13, s[60:63], s72 offen  lds
    s_waitcnt vmcnt(12)
    s_bfe_u32 s72, s81, 0x40000
    s_mul_i32 s72, s72, 131072
    s_add_u32 s72, s72, s92
    s_add_u32 m0, s73, 16384
    s_nop 0
    buffer_load_dwordx4 v12, s[60:63], s72 offen  lds
    s_add_u32 s72, s72, 32768
    s_add_u32 m0, s73, 17408
    s_nop 0
    buffer_load_dwordx4 v13, s[60:63], s72 offen  lds
    s_add_u32 s72, s72, 32768
    s_add_u32 m0, s73, 18432
    s_nop 0
    buffer_load_dwordx4 v12, s[60:63], s72 offen  lds
    s_add_u32 s72, s72, 32768
    s_add_u32 m0, s73, 19456
    s_nop 0
    buffer_load_dwordx4 v13, s[60:63], s72 offen  lds
    v_mov_b32 v20, 1
    s_mov_b64 exec, 1
    ds_add_u32 v0, v20 offset:28
    s_mov_b64 exec, -1
    s_waitcnt vmcnt(12)
    s_waitcnt lgkmcnt(9)
    s_bfe_u32 s72, s81, 0x40004
    s_mul_i32 s72, s72, 131072
    s_add_u32 s72, s72, s92
    s_add_u32 m0, s73, 20480
    s_nop 0
    buffer_load_dwordx4 v12, s[60:63], s72 offen  lds
    s_add_u32 s72, s72, 32768
    s_add_u32 m0, s73, 21504
    s_nop 0
    buffer_load_dwordx4 v13, s[60:63], s72 offen  lds
    s_add_u32 s72, s72, 32768
    s_add_u32 m0, s73, 22528
    s_nop 0
    buffer_load_dwordx4 v12, s[60:63], s72 offen  lds
    s_add_u32 s72, s72, 32768
    s_add_u32 m0, s73, 23552
    s_nop 0
    buffer_load_dwordx4 v13, s[60:63], s72 offen  lds
    s_waitcnt vmcnt(12)
    s_waitcnt lgkmcnt(1)
    s_bfe_u32 s72, s81, 0x40008
    s_mul_i32 s72, s72, 131072
    s_add_u32 s72, s72, s92
    s_add_u32 m0, s73, 24576
    s_nop 0
    buffer_load_dwordx4 v12, s[60:63], s72 offen  lds
    s_add_u32 s72, s72, 32768
    s_add_u32 m0, s73, 25600
    s_nop 0
    buffer_load_dwordx4 v13, s[60:63], s72 offen  lds
    s_add_u32 s72, s72, 32768
    s_add_u32 m0, s73, 26624
    s_nop 0
    buffer_load_dwordx4 v12, s[60:63], s72 offen  lds
    s_add_u32 s72, s72, 32768
    s_add_u32 m0, s73, 27648
    s_nop 0
    buffer_load_dwordx4 v13, s[60:63], s72 offen  lds
    s_mov_b32 s78, 0
    s_branch Lspinf_31
Lspin_29:
    s_sleep 1
Lspinf_31:
    ds_read_b32 v20, v0 offset:32
    s_add_u32 s78, s78, 1
    s_waitcnt lgkmcnt(0)
    v_readfirstlane_b32 s79, v20
    s_cmp_gt_u32 s78, 0x200000
    s_cbranch_scc1 Lspind_30
    s_cmp_lt_u32 s79, 1
    s_cbranch_scc1 Lspin_29
Lspind_30:
    s_bfe_u32 s76, s80, 0x40000
    s_mul_i32 s76, s76, 40960
    s_add_u32 s76, s76, s86
    buffer_load_dwordx4 v[24:27], v19, s[68:71], s76 offen offset:0 sc1
    buffer_load_dwordx4 v[28:31], v19, s[68:71], s76 offen offset:256 sc1
    buffer_load_dwordx4 v[32:35], v19, s[68:71], s76 offen offset:512 sc1
    buffer_load_dwordx4 v[36:39], v19, s[68:71], s76 offen offset:768 sc1
    buffer_load_dwordx4 v[40:43], v19, s[68:71], s76 offen offset:1024 sc1
    s_bfe_u32 s76, s80, 0x40004
    s_mul_i32 s76, s76, 40960
    s_add_u32 s76, s76, s86
    buffer_load_dwordx4 v[44:47], v19, s[68:71], s76 offen offset:0 sc1
    buffer_load_dwordx4 v[48:51], v19, s[68:71], s76 offen offset:256 sc1
    buffer_load_dwordx4 v[52:55], v19, s[68:71], s76 offen offset:512 sc1
    buffer_load_dwordx4 v[56:59], v19, s[68:71], s76 offen offset:768 sc1
    buffer_load_dwordx4 v[60:63], v19, s[68:71], s76 offen offset:1024 sc1
    s_bfe_u32 s76, s80, 0x40008
    s_mul_i32 s76, s76, 40960
    s_add_u32 s76, s76, s86
    buffer_load_dwordx4 v[64:67], v19, s[68:71], s76 offen offset:0 sc1
    buffer_load_dwordx4 v[68:71], v19, s[68:71], s76 offen offset:256 sc1
    buffer_load_dwordx4 v[72:75], v19, s[68:71], s76 offen offset:512 sc1
    buffer_load_dwordx4 v[76:79], v19, s[68:71], s76 offen offset:768 sc1
    buffer_load_dwordx4 v[80:83], v19, s[68:71], s76 offen offset:1024 sc1
    s_waitcnt vmcnt(14)
    v_mfma_f32_16x16x32_bf16 v[84:87], v[24:27], a[0:3], v[84:87]
    v_mfma_f32_16x16x32_bf16 a[68:71], v[24:27], a[4:7], 0
    s_bfe_u32 s76, s80, 0x4000c
    v_mfma_f32_16x16x32_bf16 a[72:75], v[24:27], a[8:11], 0
    s_mul_i32 s76, s76, 40960
    v_mfma_f32_16x16x32_bf16 a[76:79], v[24:27], a[12:15], 0
    s_add_u32 s76, s76, s86
    s_waitcnt vmcnt(13)
    v_mfma_f32_16x16x32_bf16 v[88:91], v[28:31], a[0:3], v[88:91]
    buffer_load_dwordx4 v[24:27], v19, s[68:71], s76 offen offset:0 sc1
    v_mfma_f32_16x16x32_bf16 a[80:83], v[28:31], a[4:7], 0
    v_mfma_f32_16x16x32_bf16 a[84:87], v[28:31], a[8:11], 0
    v_mfma_f32_16x16x32_bf16 a[88:91], v[28:31], a[12:15], 0
    s_waitcnt vmcnt(13)
    v_mfma_f32_16x16x32_bf16 v[92:95], v[32:35], a[0:3], v[92:95]
    buffer_load_dwordx4 v[28:31], v19, s[68:71], s76 offen offset:256 sc1
    v_mfma_f32_16x16x32_bf16 a[92:95], v[32:35], a[4:7], 0
    v_mfma_f32_16x16x32_bf16 a[96:99], v[32:35], a[8:11], 0
    v_mfma_f32_16x16x32_bf16 a[100:103], v[32:35], a[12:15], 0
    s_waitcnt vmcnt(13)
    v_mfma_f32_16x16x32_bf16 v[96:99], v[36:39], a[0:3], v[96:99]
    buffer_load_dwordx4 v[32:35], v19, s[68:71], s76 offen offset:512 sc1
    v_mfma_f32_16x16x32_bf16 a[104:107], v[36:39], a[4:7], 0
    v_mfma_f32_16x16x32_bf16 a[108:111], v[36:39], a[8:11], 0
    v_mfma_f32_16x16x32_bf16 a[112:115], v[36:39], a[12:15], 0
    s_waitcnt vmcnt(13)
    v_mfma_f32_16x16x32_bf16 v[100:103], v[40:43], a[0:3], v[100:103]
    buffer_load_dwordx4 v[36:39], v19, s[68:71], s76 offen offset:768 sc1
    v_mfma_f32_16x16x32_bf16 a[116:119], v[40:43], a[4:7], 0
    v_mfma_f32_16x16x32_bf16 a[120:123], v[40:43], a[8:11], 0
    v_mfma_f32_16x16x32_bf16 a[124:127], v[40:43], a[12:15], 0
    s_waitcnt vmcnt(13)
    v_mfma_f32_16x16x32_bf16 v[84:87], v[44:47], a[16:19], v[84:87]
    buffer_load_dwordx4 v[40:43], v19, s[68:71], s76 offen offset:1024 sc1
    v_mfma_f32_16x16x32_bf16 a[68:71], v[44:47], a[20:23], a[68:71]
    s_bfe_u32 s76, s80, 0x40010
    v_mfma_f32_16x16x32_bf16 a[72:75], v[44:47], a[24:27], a[72:75]
    ds_read_b64_tr_b16 a[0:1], v14 offset:0
    s_mul_i32 s76, s76, 40960
    v_mfma_f32_16x16x32_bf16 a[76:79], v[44:47], a[28:31], a[76:79]
    s_add_u32 s76, s76, s86
    s_waitcnt vmcnt(13)
    v_mfma_f32_16x16x32_bf16 v[88:91], v[48:51], a[16:19], v[88:91]
    buffer_load_dwordx4 v[44:47], v19, s[68:71], s76 offen offset:0 sc1
    v_mfma_f32_16x16x32_bf16 a[80:83], v[48:51], a[20:23], a[80:83]
    ds_read_b64_tr_b16 a[2:3], v14 offset:512
    ds_read_b64_tr_b16 a[4:5], v15 offset:0
    v_mfma_f32_16x16x32_bf16 a[84:87], v[48:51], a[24:27], a[84:87]
    ds_read_b64_tr_b16 a[6:7], v15 offset:512
    ds_read_b64_tr_b16 a[8:9], v16 offset:0
    v_mfma_f32_16x16x32_bf16 a[88:91], v[48:51], a[28:31], a[88:91]
    ds_read_b64_tr_b16 a[10:11], v16 offset:512
    s_waitcnt vmcnt(13)
    v_mfma_f32_16x16x32_bf16 v[92:95], v[52:55], a[16:19], v[92:95]
    buffer_load_dwordx4 v[48:51], v19, s[68:71], s76 offen offset:256 sc1
    v_mfma_f32_16x16x32_bf16 a[92:95], v[52:55], a[20:23], a[92:95]
    ds_read_b64_tr_b16 a[12:13], v17 offset:0
    ds_read_b64_tr_b16 a[14:15], v17 offset:512
    v_mfma_f32_16x16x32_bf16 a[96:99], v[52:55], a[24:27], a[96:99]
    v_mfma_f32_16x16x32_bf16 a[100:103], v[52:55], a[28:31], a[100:103]
    s_waitcnt vmcnt(13)
    v_mfma_f32_16x16x32_bf16 v[96:99], v[56:59], a[16:19], v[96:99]
    buffer_load_dwordx4 v[52:55], v19, s[68:71], s76 offen offset:512 sc1
    v_mfma_f32_16x16x32_bf16 a[104:107], v[56:59], a[20:23], a[104:107]
    v_mfma_f32_16x16x32_bf16 a[108:111], v[56:59], a[24:27], a[108:111]
    v_mfma_f32_16x16x32_bf16 a[112:115], v[56:59], a[28:31], a[112:115]
    s_waitcnt vmcnt(13)
    v_mfma_f32_16x16x32_bf16 v[100:103], v[60:63], a[16:19], v[100:103]
    buffer_load_dwordx4 v[56:59], v19, s[68:71], s76 offen offset:768 sc1
    v_mfma_f32_16x16x32_bf16 a[116:119], v[60:63], a[20:23], a[116:119]
    v_mfma_f32_16x16x32_bf16 a[120:123], v[60:63], a[24:27], a[120:123]
    v_mfma_f32_16x16x32_bf16 a[124:127], v[60:63], a[28:31], a[124:127]
    s_waitcnt vmcnt(13)
    v_mfma_f32_16x16x32_bf16 v[84:87], v[64:67], a[32:35], v[84:87]
    buffer_load_dwordx4 v[60:63], v19, s[68:71], s76 offen offset:1024 sc1
    v_mfma_f32_16x16x32_bf16 a[68:71], v[64:67], a[36:39], a[68:71]
    s_waitcnt lgkmcnt(0)
    s_bfe_u32 s72, s81, 0x4000c
    s_bfe_u32 s76, s80, 0x40014
    v_mfma_f32_16x16x32_bf16 a[72:75], v[64:67], a[40:43], a[72:75]
    s_mul_i32 s72, s72, 131072
    s_add_u32 s72, s72, s92
    s_mul_i32 s76, s76, 40960
    v_mfma_f32_16x16x32_bf16 a[76:79], v[64:67], a[44:47], a[76:79]
    s_add_u32 s76, s76, s86
    s_waitcnt vmcnt(13)
    v_mfma_f32_16x16x32_bf16 v[88:91], v[68:71], a[32:35], v[88:91]
    buffer_load_dwordx4 v[64:67], v19, s[68:71], s76 offen offset:0 sc1
    v_mfma_f32_16x16x32_bf16 a[80:83], v[68:71], a[36:39], a[80:83]
    s_add_u32 m0, s73, 0
    s_nop 0
    buffer_load_dwordx4 v12, s[60:63], s72 offen  lds
    v_mfma_f32_16x16x32_bf16 a[84:87], v[68:71], a[40:43], a[84:87]
    s_add_u32 s72, s72, 32768
    v_mfma_f32_16x16x32_bf16 a[88:91], v[68:71], a[44:47], a[88:91]
    s_waitcnt vmcnt(14)
    v_mfma_f32_16x16x32_bf16 v[92:95], v[72:75], a[32:35], v[92:95]
    buffer_load_dwordx4 v[68:71], v19, s[68:71], s76 offen offset:256 sc1
    v_mfma_f32_16x16x32_bf16 a[92:95], v[72:75], a[36:39], a[92:95]
    s_add_u32 m0, s73, 1024
    s_nop 0
    buffer_load_dwordx4 v13, s[60:63], s72 offen  lds
    v_mfma_f32_16x16x32_bf16 a[96:99], v[72:75], a[40:43], a[96:99]
    s_add_u32 s72, s72, 32768
    v_mfma_f32_16x16x32_bf16 a[100:103], v[72:75], a[44:47], a[100:103]
    s_waitcnt vmcnt(15)
    v_mfma_f32_16x16x32_bf16 v[96:99], v[76:79], a[32:35], v[96:99]
    buffer_load_dwordx4 v[72:75], v19, s[68:71], s76 offen offset:512 sc1
    v_mfma_f32_16x16x32_bf16 a[104:107], v[76:79], a[36:39], a[104:107]
    s_add_u32 m0, s73, 2048
    s_nop 0
    buffer_load_dwordx4 v12, s[60:63], s72 offen  lds
    v_mfma_f32_16x16x32_bf16 a[108:111], v[76:79], a[40:43], a[108:111]
    s_add_u32 s72, s72, 32768
    v_mfma_f32_16x16x32_bf16 a[112:115], v[76:79], a[44:47], a[112:115]
    s_waitcnt vmcnt(16)
    v_mfma_f32_16x16x32_bf16 v[100:103], v[80:83], a[32:35], v[100:103]
    buffer_load_dwordx4 v[76:79], v19, s[68:71], s76 offen offset:768 sc1
    v_mfma_f32_16x16x32_bf16 a[116:119], v[80:83], a[36:39], a[116:119]
    s_add_u32 m0, s73, 3072
    s_nop 0
    buffer_load_dwordx4 v13, s[60:63], s72 offen  lds
    v_mfma_f32_16x16x32_bf16 a[120:123], v[80:83], a[40:43], a[120:123]
    ds_read_b64_tr_b16 a[16:17], v14 offset:4096
    ds_read_b64_tr_b16 a[18:19], v14 offset:4608
    v_mfma_f32_16x16x32_bf16 a[124:127], v[80:83], a[44:47], a[124:127]
    ds_read_b64_tr_b16 a[20:21], v15 offset:4096
    ds_read_b64_tr_b16 a[22:23], v15 offset:4608
    ds_read_b64_tr_b16 a[24:25], v16 offset:4096
    ds_read_b64_tr_b16 a[26:27], v16 offset:4608
    ds_read_b64_tr_b16 a[28:29], v17 offset:4096
    ds_read_b64_tr_b16 a[30:31], v17 offset:4608
    s_waitcnt vmcnt(17)
    v_mfma_f32_16x16x32_bf16 v[84:87], v[24:27], a[48:51], v[84:87]
    buffer_load_dwordx4 v[80:83], v19, s[68:71], s76 offen offset:1024 sc1
    v_mfma_f32_16x16x32_bf16 a[68:71], v[24:27], a[52:55], a[68:71]
    s_bfe_u32 s76, s80, 0x40018
    v_mfma_f32_16x16x32_bf16 a[72:75], v[24:27], a[56:59], a[72:75]
    ds_read_b64_tr_b16 a[32:33], v14 offset:8192
    s_mul_i32 s76, s76, 40960
    v_mfma_f32_16x16x32_bf16 a[76:79], v[24:27], a[60:63], a[76:79]
    s_add_u32 s76, s76, s86
    s_waitcnt vmcnt(17)
    v_mfma_f32_16x16x32_bf16 v[88:91], v[28:31], a[48:51], v[88:91]
    buffer_load_dwordx4 v[24:27], v19, s[68:71], s76 offen offset:0 sc1
    v_mfma_f32_16x16x32_bf16 a[80:83], v[28:31], a[52:55], a[80:83]
    ds_read_b64_tr_b16 a[34:35], v14 offset:8704
    ds_read_b64_tr_b16 a[36:37], v15 offset:8192
    v_mfma_f32_16x16x32_bf16 a[84:87], v[28:31], a[56:59], a[84:87]
    ds_read_b64_tr_b16 a[38:39], v15 offset:8704
    ds_read_b64_tr_b16 a[40:41], v16 offset:8192
    v_mfma_f32_16x16x32_bf16 a[88:91], v[28:31], a[60:63], a[88:91]
    ds_read_b64_tr_b16 a[42:43], v16 offset:8704
    s_waitcnt vmcnt(17)
    v_mfma_f32_16x16x32_bf16 v[92:95], v[32:35], a[48:51], v[92:95]
    buffer_load_dwordx4 v[28:31], v19, s[68:71], s76 offen offset:256 sc1
    v_mfma_f32_16x16x32_bf16 a[92:95], v[32:35], a[52:55], a[92:95]
    ds_read_b64_tr_b16 a[44:45], v17 offset:8192
    ds_read_b64_tr_b16 a[46:47], v17 offset:8704
    v_mfma_f32_16x16x32_bf16 a[96:99], v[32:35], a[56:59], a[96:99]
    v_mfma_f32_16x16x32_bf16 a[100:103], v[32:35], a[60:63], a[100:103]
    s_waitcnt vmcnt(17)
    v_mfma_f32_16x16x32_bf16 v[96:99], v[36:39], a[48:51], v[96:99]
    buffer_load_dwordx4 v[32:35], v19, s[68:71], s76 offen offset:512 sc1
    v_mfma_f32_16x16x32_bf16 a[104:107], v[36:39], a[52:55], a[104:107]
    v_mfma_f32_16x16x32_bf16 a[108:111], v[36:39], a[56:59], a[108:111]
    v_mfma_f32_16x16x32_bf16 a[112:115], v[36:39], a[60:63], a[112:115]
    s_waitcnt vmcnt(17)
    v_mfma_f32_16x16x32_bf16 v[100:103], v[40:43], a[48:51], v[100:103]
    buffer_load_dwordx4 v[36:39], v19, s[68:71], s76 offen offset:768 sc1
    v_mfma_f32_16x16x32_bf16 a[116:119], v[40:43], a[52:55], a[116:119]
    v_mfma_f32_16x16x32_bf16 a[120:123], v[40:43], a[56:59], a[120:123]
    v_mfma_f32_16x16x32_bf16 a[124:127], v[40:43], a[60:63], a[124:127]
    s_waitcnt vmcnt(17)
    v_mfma_f32_16x16x32_bf16 v[84:87], v[44:47], a[0:3], v[84:87]
    buffer_load_dwordx4 v[40:43], v19, s[68:71], s76 offen offset:1024 sc1
    v_mfma_f32_16x16x32_bf16 a[68:71], v[44:47], a[4:7], a[68:71]
    s_bfe_u32 s76, s80, 0x4001c
    v_mfma_f32_16x16x32_bf16 a[72:75], v[44:47], a[8:11], a[72:75]
    ds_read_b64_tr_b16 a[48:49], v14 offset:12288
    s_mul_i32 s76, s76, 40960
    v_mfma_f32_16x16x32_bf16 a[76:79], v[44:47], a[12:15], a[76:79]
    s_add_u32 s76, s76, s86
    s_waitcnt vmcnt(17)
    v_mfma_f32_16x16x32_bf16 v[88:91], v[48:51], a[0:3], v[88:91]
    buffer_load_dwordx4 v[44:47], v19, s[68:71], s76 offen offset:0 sc1
    v_mfma_f32_16x16x32_bf16 a[80:83], v[48:51], a[4:7], a[80:83]
    ds_read_b64_tr_b16 a[50:51], v14 offset:12800
    ds_read_b64_tr_b16 a[52:53], v15 offset:12288
    v_mfma_f32_16x16x32_bf16 a[84:87], v[48:51], a[8:11], a[84:87]
    ds_read_b64_tr_b16 a[54:55], v15 offset:12800
    ds_read_b64_tr_b16 a[56:57], v16 offset:12288
    v_mfma_f32_16x16x32_bf16 a[88:91], v[48:51], a[12:15], a[88:91]
    ds_read_b64_tr_b16 a[58:59], v16 offset:12800
    s_waitcnt vmcnt(17)
    v_mfma_f32_16x16x32_bf16 v[92:95], v[52:55], a[0:3], v[92:95]
    buffer_load_dwordx4 v[48:51], v19, s[68:71], s76 offen offset:256 sc1
    v_mfma_f32_16x16x32_bf16 a[92:95], v[52:55], a[4:7], a[92:95]
    ds_read_b64_tr_b16 a[60:61], v17 offset:12288
    ds_read_b64_tr_b16 a[62:63], v17 offset:12800
    v_mfma_f32_16x16x32_bf16 a[96:99], v[52:55], a[8:11], a[96:99]
    v_mfma_f32_16x16x32_bf16 a[100:103], v[52:55], a[12:15], a[100:103]
    s_waitcnt vmcnt(17)
    v_mfma_f32_16x16x32_bf16 v[96:99], v[56:59], a[0:3], v[96:99]
    buffer_load_dwordx4 v[52:55], v19, s[68:71], s76 offen offset:512 sc1
    v_mfma_f32_16x16x32_bf16 a[104:107], v[56:59], a[4:7], a[104:107]
    v_mfma_f32_16x16x32_bf16 a[108:111], v[56:59], a[8:11], a[108:111]
    v_mfma_f32_16x16x32_bf16 a[112:115], v[56:59], a[12:15], a[112:115]
    s_waitcnt vmcnt(17)
    v_mfma_f32_16x16x32_bf16 v[100:103], v[60:63], a[0:3], v[100:103]
    buffer_load_dwordx4 v[56:59], v19, s[68:71], s76 offen offset:768 sc1
    v_mfma_f32_16x16x32_bf16 a[116:119], v[60:63], a[4:7], a[116:119]
    v_mfma_f32_16x16x32_bf16 a[120:123], v[60:63], a[8:11], a[120:123]
    v_mfma_f32_16x16x32_bf16 a[124:127], v[60:63], a[12:15], a[124:127]
    s_waitcnt lgkmcnt(15)
    s_waitcnt vmcnt(17)
    v_mfma_f32_16x16x32_bf16 v[84:87], v[64:67], a[16:19], v[84:87]
    buffer_load_dwordx4 v[60:63], v19, s[68:71], s76 offen offset:1024 sc1
    v_mfma_f32_16x16x32_bf16 a[68:71], v[64:67], a[20:23], a[68:71]
    s_bfe_u32 s76, s81, 0x40000
    v_mfma_f32_16x16x32_bf16 a[72:75], v[64:67], a[24:27], a[72:75]
    ds_read_b64_tr_b16 a[0:1], v14 offset:16384
    s_mul_i32 s76, s76, 40960
    v_mfma_f32_16x16x32_bf16 a[76:79], v[64:67], a[28:31], a[76:79]
    s_add_u32 s76, s76, s86
    s_waitcnt vmcnt(16)
    v_mfma_f32_16x16x32_bf16 v[88:91], v[68:71], a[16:19], v[88:91]
    buffer_load_dwordx4 v[64:67], v19, s[68:71], s76 offen offset:0 sc1
    v_mfma_f32_16x16x32_bf16 a[80:83], v[68:71], a[20:23], a[80:83]
    ds_read_b64_tr_b16 a[2:3], v14 offset:16896
    ds_read_b64_tr_b16 a[4:5], v15 offset:16384
    v_mfma_f32_16x16x32_bf16 a[84:87], v[68:71], a[24:27], a[84:87]
    ds_read_b64_tr_b16 a[6:7], v15 offset:16896
    ds_read_b64_tr_b16 a[8:9], v16 offset:16384
    v_mfma_f32_16x16x32_bf16 a[88:91], v[68:71], a[28:31], a[88:91]
    ds_read_b64_tr_b16 a[10:11], v16 offset:16896
    s_waitcnt vmcnt(15)
    v_mfma_f32_16x16x32_bf16 v[92:95], v[72:75], a[16:19], v[92:95]
    buffer_load_dwordx4 v[68:71], v19, s[68:71], s76 offen offset:256 sc1
    v_mfma_f32_16x16x32_bf16 a[92:95], v[72:75], a[20:23], a[92:95]
    ds_read_b64_tr_b16 a[12:13], v17 offset:16384
    ds_read_b64_tr_b16 a[14:15], v17 offset:16896
    v_mfma_f32_16x16x32_bf16 a[96:99], v[72:75], a[24:27], a[96:99]
    v_mfma_f32_16x16x32_bf16 a[100:103], v[72:75], a[28:31], a[100:103]
    s_waitcnt vmcnt(14)
    v_mfma_f32_16x16x32_bf16 v[96:99], v[76:79], a[16:19], v[96:99]
    buffer_load_dwordx4 v[72:75], v19, s[68:71], s76 offen offset:512 sc1
    v_mfma_f32_16x16x32_bf16 a[104:107], v[76:79], a[20:23], a[104:107]
    v_mfma_f32_16x16x32_bf16 a[108:111], v[76:79], a[24:27], a[108:111]
    v_mfma_f32_16x16x32_bf16 a[112:115], v[76:79], a[28:31], a[112:115]
    s_waitcnt vmcnt(13)
    v_mfma_f32_16x16x32_bf16 v[100:103], v[80:83], a[16:19], v[100:103]
    buffer_load_dwordx4 v[76:79], v19, s[68:71], s76 offen offset:768 sc1
    v_mfma_f32_16x16x32_bf16 a[116:119], v[80:83], a[20:23], a[116:119]
    v_mfma_f32_16x16x32_bf16 a[120:123], v[80:83], a[24:27], a[120:123]
    v_mfma_f32_16x16x32_bf16 a[124:127], v[80:83], a[28:31], a[124:127]
    v_mov_b32 v20, 1
    s_mov_b64 exec, 1
    ds_add_u32 v0, v20 offset:36
    s_mov_b64 exec, -1
    s_waitcnt lgkmcnt(15)
    s_waitcnt vmcnt(13)
    v_mfma_f32_16x16x32_bf16 v[84:87], v[24:27], a[32:35], v[84:87]
    buffer_load_dwordx4 v[80:83], v19, s[68:71], s76 offen offset:1024 sc1
    v_mfma_f32_16x16x32_bf16 a[68:71], v[24:27], a[36:39], a[68:71]
    s_bfe_u32 s76, s81, 0x40004
    v_mfma_f32_16x16x32_bf16 a[72:75], v[24:27], a[40:43], a[72:75]
    ds_read_b64_tr_b16 a[16:17], v14 offset:20480
    s_mul_i32 s76, s76, 40960
    v_mfma_f32_16x16x32_bf16 a[76:79], v[24:27], a[44:47], a[76:79]
    s_add_u32 s76, s76, s86
    s_waitcnt vmcnt(13)
    v_mfma_f32_16x16x32_bf16 v[88:91], v[28:31], a[32:35], v[88:91]
    buffer_load_dwordx4 v[24:27], v19, s[68:71], s76 offen offset:0 sc1
    v_mfma_f32_16x16x32_bf16 a[80:83], v[28:31], a[36:39], a[80:83]
    ds_read_b64_tr_b16 a[18:19], v14 offset:20992
    ds_read_b64_tr_b16 a[20:21], v15 offset:20480
    v_mfma_f32_16x16x32_bf16 a[84:87], v[28:31], a[40:43], a[84:87]
    ds_read_b64_tr_b16 a[22:23], v15 offset:20992
    ds_read_b64_tr_b16 a[24:25], v16 offset:20480
    v_mfma_f32_16x16x32_bf16 a[88:91], v[28:31], a[44:47], a[88:91]
    ds_read_b64_tr_b16 a[26:27], v16 offset:20992
    s_waitcnt vmcnt(13)
    v_mfma_f32_16x16x32_bf16 v[92:95], v[32:35], a[32:35], v[92:95]
    buffer_load_dwordx4 v[28:31], v19, s[68:71], s76 offen offset:256 sc1
    v_mfma_f32_16x16x32_bf16 a[92:95], v[32:35], a[36:39], a[92:95]
    ds_read_b64_tr_b16 a[28:29], v17 offset:20480
    ds_read_b64_tr_b16 a[30:31], v17 offset:20992
    v_mfma_f32_16x16x32_bf16 a[96:99], v[32:35], a[40:43], a[96:99]
    v_mfma_f32_16x16x32_bf16 a[100:103], v[32:35], a[44:47], a[100:103]
    s_waitcnt vmcnt(13)
    v_mfma_f32_16x16x32_bf16 v[96:99], v[36:39], a[32:35], v[96:99]
    buffer_load_dwordx4 v[32:35], v19, s[68:71], s76 offen offset:512 sc1
    v_mfma_f32_16x16x32_bf16 a[104:107], v[36:39], a[36:39], a[104:107]
    v_mfma_f32_16x16x32_bf16 a[108:111], v[36:39], a[40:43], a[108:111]
    v_mfma_f32_16x16x32_bf16 a[112:115], v[36:39], a[44:47], a[112:115]
    s_waitcnt vmcnt(13)
    v_mfma_f32_16x16x32_bf16 v[100:103], v[40:43], a[32:35], v[100:103]
    buffer_load_dwordx4 v[36:39], v19, s[68:71], s76 offen offset:768 sc1
    v_mfma_f32_16x16x32_bf16 a[116:119], v[40:43], a[36:39], a[116:119]
    v_mfma_f32_16x16x32_bf16 a[120:123], v[40:43], a[40:43], a[120:123]
    v_mfma_f32_16x16x32_bf16 a[124:127], v[40:43], a[44:47], a[124:127]
    s_waitcnt lgkmcnt(15)
    s_waitcnt vmcnt(13)
    v_mfma_f32_16x16x32_bf16 v[84:87], v[44:47], a[48:51], v[84:87]
    buffer_load_dwordx4 v[40:43], v19, s[68:71], s76 offen offset:1024 sc1
    v_mfma_f32_16x16x32_bf16 a[68:71], v[44:47], a[52:55], a[68:71]
    s_bfe_u32 s76, s81, 0x40008
    v_mfma_f32_16x16x32_bf16 a[72:75], v[44:47], a[56:59], a[72:75]
    ds_read_b64_tr_b16 a[32:33], v14 offset:24576
    s_mul_i32 s76, s76, 40960
    v_mfma_f32_16x16x32_bf16 a[76:79], v[44:47], a[60:63], a[76:79]
    s_add_u32 s76, s76, s86
    s_waitcnt vmcnt(13)
    v_mfma_f32_16x16x32_bf16 v[88:91], v[48:51], a[48:51], v[88:91]
    buffer_load_dwordx4 v[44:47], v19, s[68:71], s76 offen offset:0 sc1
    v_mfma_f32_16x16x32_bf16 a[80:83], v[48:51], a[52:55], a[80:83]
    ds_read_b64_tr_b16 a[34:35], v14 offset:25088
    ds_read_b64_tr_b16 a[36:37], v15 offset:24576
    v_mfma_f32_16x16x32_bf16 a[84:87], v[48:51], a[56:59], a[84:87]
    ds_read_b64_tr_b16 a[38:39], v15 offset:25088
    ds_read_b64_tr_b16 a[40:41], v16 offset:24576
    v_mfma_f32_16x16x32_bf16 a[88:91], v[48:51], a[60:63], a[88:91]
    ds_read_b64_tr_b16 a[42:43], v16 offset:25088
    s_waitcnt vmcnt(13)
    v_mfma_f32_16x16x32_bf16 v[92:95], v[52:55], a[48:51], v[92:95]
    buffer_load_dwordx4 v[48:51], v19, s[68:71], s76 offen offset:256 sc1
    v_mfma_f32_16x16x32_bf16 a[92:95], v[52:55], a[52:55], a[92:95]
    ds_read_b64_tr_b16 a[44:45], v17 offset:24576
    ds_read_b64_tr_b16 a[46:47], v17 offset:25088
    v_mfma_f32_16x16x32_bf16 a[96:99], v[52:55], a[56:59], a[96:99]
    v_mfma_f32_16x16x32_bf16 a[100:103], v[52:55], a[60:63], a[100:103]
    s_waitcnt vmcnt(13)
    v_mfma_f32_16x16x32_bf16 v[96:99], v[56:59], a[48:51], v[96:99]
    buffer_load_dwordx4 v[52:55], v19, s[68:71], s76 offen offset:512 sc1
    v_mfma_f32_16x16x32_bf16 a[104:107], v[56:59], a[52:55], a[104:107]
    v_mfma_f32_16x16x32_bf16 a[108:111], v[56:59], a[56:59], a[108:111]
    v_mfma_f32_16x16x32_bf16 a[112:115], v[56:59], a[60:63], a[112:115]
    s_waitcnt vmcnt(13)
    v_mfma_f32_16x16x32_bf16 v[100:103], v[60:63], a[48:51], v[100:103]
    buffer_load_dwordx4 v[56:59], v19, s[68:71], s76 offen offset:768 sc1
    v_mfma_f32_16x16x32_bf16 a[116:119], v[60:63], a[52:55], a[116:119]
    v_mfma_f32_16x16x32_bf16 a[120:123], v[60:63], a[56:59], a[120:123]
    v_mfma_f32_16x16x32_bf16 a[124:127], v[60:63], a[60:63], a[124:127]
    s_waitcnt lgkmcnt(15)
    s_waitcnt vmcnt(13)
    v_mfma_f32_16x16x32_bf16 v[84:87], v[64:67], a[0:3], v[84:87]
    buffer_load_dwordx4 v[60:63], v19, s[68:71], s76 offen offset:1024 sc1
    v_mfma_f32_16x16x32_bf16 a[68:71], v[64:67], a[4:7], a[68:71]
    s_bfe_u32 s76, s81, 0x4000c
    v_mfma_f32_16x16x32_bf16 a[72:75], v[64:67], a[8:11], a[72:75]
    ds_read_b64_tr_b16 a[48:49], v14 offset:0
    s_mul_i32 s76, s76, 40960
    v_mfma_f32_16x16x32_bf16 a[76:79], v[64:67], a[12:15], a[76:79]
    s_add_u32 s76, s76, s86
    s_waitcnt vmcnt(13)
    v_mfma_f32_16x16x32_bf16 v[88:91], v[68:71], a[0:3], v[88:91]
    buffer_load_dwordx4 v[64:67], v19, s[68:71], s76 offen offset:0 sc1
    v_mfma_f32_16x16x32_bf16 a[80:83], v[68:71], a[4:7], a[80:83]
    ds_read_b64_tr_b16 a[50:51], v14 offset:512
    ds_read_b64_tr_b16 a[52:53], v15 offset:0
    v_mfma_f32_16x16x32_bf16 a[84:87], v[68:71], a[8:11], a[84:87]
    ds_read_b64_tr_b16 a[54:55], v15 offset:512
    ds_read_b64_tr_b16 a[56:57], v16 offset:0
    v_mfma_f32_16x16x32_bf16 a[88:91], v[68:71], a[12:15], a[88:91]
    ds_read_b64_tr_b16 a[58:59], v16 offset:512
    s_waitcnt vmcnt(13)
    v_mfma_f32_16x16x32_bf16 v[92:95], v[72:75], a[0:3], v[92:95]
    buffer_load_dwordx4 v[68:71], v19, s[68:71], s76 offen offset:256 sc1
    v_mfma_f32_16x16x32_bf16 a[92:95], v[72:75], a[4:7], a[92:95]
    ds_read_b64_tr_b16 a[60:61], v17 offset:0
    ds_read_b64_tr_b16 a[62:63], v17 offset:512
    v_mfma_f32_16x16x32_bf16 a[96:99], v[72:75], a[8:11], a[96:99]
    v_mfma_f32_16x16x32_bf16 a[100:103], v[72:75], a[12:15], a[100:103]
    s_waitcnt vmcnt(13)
    v_mfma_f32_16x16x32_bf16 v[96:99], v[76:79], a[0:3], v[96:99]
    buffer_load_dwordx4 v[72:75], v19, s[68:71], s76 offen offset:512 sc1
    v_mfma_f32_16x16x32_bf16 a[104:107], v[76:79], a[4:7], a[104:107]
    v_mfma_f32_16x16x32_bf16 a[108:111], v[76:79], a[8:11], a[108:111]
    v_mfma_f32_16x16x32_bf16 a[112:115], v[76:79], a[12:15], a[112:115]
    s_waitcnt vmcnt(13)
    v_mfma_f32_16x16x32_bf16 v[100:103], v[80:83], a[0:3], v[100:103]
    buffer_load_dwordx4 v[76:79], v19, s[68:71], s76 offen offset:768 sc1
    v_mfma_f32_16x16x32_bf16 a[116:119], v[80:83], a[4:7], a[116:119]
    v_mfma_f32_16x16x32_bf16 a[120:123], v[80:83], a[8:11], a[120:123]
    v_mfma_f32_16x16x32_bf16 a[124:127], v[80:83], a[12:15], a[124:127]
    s_waitcnt lgkmcnt(15)
    s_waitcnt vmcnt(13)
    v_mfma_f32_16x16x32_bf16 v[84:87], v[24:27], a[16:19], v[84:87]
    buffer_load_dwordx4 v[80:83], v19, s[68:71], s76 offen offset:1024 sc1
    v_mfma_f32_16x16x32_bf16 a[68:71], v[24:27], a[20:23], a[68:71]
    v_mfma_f32_16x16x32_bf16 a[72:75], v[24:27], a[24:27], a[72:75]
    v_mfma_f32_16x16x32_bf16 a[76:79], v[24:27], a[28:31], a[76:79]
    s_waitcnt vmcnt(13)
    v_mfma_f32_16x16x32_bf16 a[80:83], v[28:31], a[20:23], a[80:83]
    v_mfma_f32_16x16x32_bf16 a[84:87], v[28:31], a[24:27], a[84:87]
    v_mfma_f32_16x16x32_bf16 a[88:91], v[28:31], a[28:31], a[88:91]
    s_waitcnt vmcnt(12)
    v_mfma_f32_16x16x32_bf16 a[92:95], v[32:35], a[20:23], a[92:95]
    v_mfma_f32_16x16x32_bf16 a[96:99], v[32:35], a[24:27], a[96:99]
    v_mfma_f32_16x16x32_bf16 a[100:103], v[32:35], a[28:31], a[100:103]
    s_waitcnt vmcnt(11)
    v_mfma_f32_16x16x32_bf16 a[104:107], v[36:39], a[20:23], a[104:107]
    v_mfma_f32_16x16x32_bf16 a[108:111], v[36:39], a[24:27], a[108:111]
    v_mfma_f32_16x16x32_bf16 a[112:115], v[36:39], a[28:31], a[112:115]
    s_waitcnt vmcnt(10)
    v_mfma_f32_16x16x32_bf16 a[116:119], v[40:43], a[20:23], a[116:119]
    v_mfma_f32_16x16x32_bf16 a[120:123], v[40:43], a[24:27], a[120:123]
    v_mfma_f32_16x16x32_bf16 a[124:127], v[40:43], a[28:31], a[124:127]
    s_waitcnt lgkmcnt(8)
    s_waitcnt vmcnt(9)
    v_mfma_f32_16x16x32_bf16 a[68:71], v[44:47], a[36:39], a[68:71]
    v_mfma_f32_16x16x32_bf16 a[72:75], v[44:47], a[40:43], a[72:75]
    v_mfma_f32_16x16x32_bf16 a[76:79], v[44:47], a[44:47], a[76:79]
    s_waitcnt vmcnt(8)
    v_mfma_f32_16x16x32_bf16 a[80:83], v[48:51], a[36:39], a[80:83]
    v_mfma_f32_16x16x32_bf16 a[84:87], v[48:51], a[40:43], a[84:87]
    v_mfma_f32_16x16x32_bf16 a[88:91], v[48:51], a[44:47], a[88:91]
    s_waitcnt vmcnt(7)
    v_mfma_f32_16x16x32_bf16 a[92:95], v[52:55], a[36:39], a[92:95]
    v_mfma_f32_16x16x32_bf16 a[96:99], v[52:55], a[40:43], a[96:99]
    v_mfma_f32_16x16x32_bf16 a[100:103], v[52:55], a[44:47], a[100:103]
    s_waitcnt vmcnt(6)
    v_mfma_f32_16x16x32_bf16 a[104:107], v[56:59], a[36:39], a[104:107]
    v_mfma_f32_16x16x32_bf16 a[108:111], v[56:59], a[40:43], a[108:111]
    v_mfma_f32_16x16x32_bf16 a[112:115], v[56:59], a[44:47], a[112:115]
    s_waitcnt vmcnt(5)
    v_mfma_f32_16x16x32_bf16 a[116:119], v[60:63], a[36:39], a[116:119]
    v_mfma_f32_16x16x32_bf16 a[120:123], v[60:63], a[40:43], a[120:123]
    v_mfma_f32_16x16x32_bf16 a[124:127], v[60:63], a[44:47], a[124:127]
    s_mov_b32 s78, 0
    s_branch Lspinf_34
Lspin_32:
    s_sleep 2
Lspinf_34:
    ds_read_b32 v20, v0 offset:40
    s_add_u32 s78, s78, 1
    s_waitcnt lgkmcnt(0)
    v_readfirstlane_b32 s79, v20
    s_cmp_gt_u32 s78, 0x200000
    s_cbranch_scc1 Lspind_33
    s_cmp_lt_u32 s79, 1
    s_cbranch_scc1 Lspin_32
Lspind_33:
    buffer_load_dwordx4 a[0:3], v109, s[68:71], s88 offen sc1
    s_add_u32 s88, s88, 65536
    buffer_load_dwordx4 a[4:7], v115, s[68:71], s88 offen sc1
    s_add_u32 s88, s88, 65536
    buffer_load_dwordx4 a[8:11], v109, s[68:71], s88 offen sc1
    s_add_u32 s88, s88, 65536
    buffer_load_dwordx4 a[12:15], v115, s[68:71], s88 offen sc1
    s_add_u32 s88, s88, 65536
    buffer_load_dwordx4 a[64:67], v109, s[68:71], s88 offen sc1
    s_add_u32 s88, s88, 65536
    v_add_u32 v21, s73, v2
    s_waitcnt vmcnt(9)
    v_mfma_f32_16x16x32_bf16 a[68:71], v[64:67], a[52:55], a[68:71]
    v_mfma_f32_16x16x32_bf16 a[72:75], v[64:67], a[56:59], a[72:75]
    v_mfma_f32_16x16x32_bf16 a[76:79], v[64:67], a[60:63], a[76:79]
    s_waitcnt vmcnt(8)
    v_mfma_f32_16x16x32_bf16 a[80:83], v[68:71], a[52:55], a[80:83]
    v_mfma_f32_16x16x32_bf16 a[84:87], v[68:71], a[56:59], a[84:87]
    v_mfma_f32_16x16x32_bf16 a[88:91], v[68:71], a[60:63], a[88:91]
    s_waitcnt vmcnt(7)
    v_mfma_f32_16x16x32_bf16 a[92:95], v[72:75], a[52:55], a[92:95]
    v_mfma_f32_16x16x32_bf16 a[96:99], v[72:75], a[56:59], a[96:99]
    v_mfma_f32_16x16x32_bf16 a[100:103], v[72:75], a[60:63], a[100:103]
    s_waitcnt vmcnt(6)
    v_mfma_f32_16x16x32_bf16 a[104:107], v[76:79], a[52:55], a[104:107]
    v_mfma_f32_16x16x32_bf16 a[108:111], v[76:79], a[56:59], a[108:111]
    v_mfma_f32_16x16x32_bf16 a[112:115], v[76:79], a[60:63], a[112:115]
    s_waitcnt vmcnt(5)
    v_mfma_f32_16x16x32_bf16 a[116:119], v[80:83], a[52:55], a[116:119]
    v_mfma_f32_16x16x32_bf16 a[120:123], v[80:83], a[56:59], a[120:123]
    v_mfma_f32_16x16x32_bf16 a[124:127], v[80:83], a[60:63], a[124:127]
    v_mfma_f32_16x16x32_bf16 v[88:91], v[28:31], a[16:19], v[88:91]
    v_mfma_f32_16x16x32_bf16 v[92:95], v[32:35], a[16:19], v[92:95]
    ds_write_b128 v21, a[72:75] offset:5120
    v_mfma_f32_16x16x32_bf16 v[96:99], v[36:39], a[16:19], v[96:99]
    v_mfma_f32_16x16x32_bf16 v[100:103], v[40:43], a[16:19], v[100:103]
    ds_write_b128 v21, a[76:79] offset:10240
    v_mfma_f32_16x16x32_bf16 v[84:87], v[44:47], a[32:35], v[84:87]
    v_mfma_f32_16x16x32_bf16 v[88:91], v[48:51], a[32:35], v[88:91]
    ds_write_b128 v21, a[84:87] offset:6144
    v_mfma_f32_16x16x32_bf16 v[92:95], v[52:55], a[32:35], v[92:95]
    v_mfma_f32_16x16x32_bf16 v[96:99], v[56:59], a[32:35], v[96:99]
    ds_write_b128 v21, a[88:91] offset:11264
    v_mfma_f32_16x16x32_bf16 v[100:103], v[60:63], a[32:35], v[100:103]
    ds_write_b128 v21, a[96:99] offset:7168
    v_mfma_f32_16x16x32_bf16 v[84:87], v[64:67], a[48:51], v[84:87]
    ds_write_b128 v21, a[100:103] offset:12288
    v_mfma_f32_16x16x32_bf16 v[88:91], v[68:71], a[48:51], v[88:91]
    ds_write_b128 v21, a[108:111] offset:8192
    v_mfma_f32_16x16x32_bf16 v[92:95], v[72:75], a[48:51], v[92:95]
    ds_write_b128 v21, a[112:115] offset:13312
    v_mfma_f32_16x16x32_bf16 v[96:99], v[76:79], a[48:51], v[96:99]
    ds_write_b128 v21, a[120:123] offset:9216
    v_mfma_f32_16x16x32_bf16 v[100:103], v[80:83], a[48:51], v[100:103]
    ds_write_b128 v21, a[124:127] offset:14336
    v_mov_b32 v20, v21
    s_xor_b32 s51, s3, 1
    s_mul_i32 s51, s51, 28672
    s_add_u32 s51, s51, 45056
    v_add_u32 v21, s51, v2
    s_xor_b32 s51, s3, 2
    s_mul_i32 s51, s51, 28672
    s_add_u32 s51, s51, 50176
    v_add_u32 v22, s51, v2
    s_xor_b32 s51, s3, 3
    s_mul_i32 s51, s51, 28672
    s_add_u32 s51, s51, 55296
    v_add_u32 v23, s51, v2
    s_waitcnt vmcnt(4)
    v_mfma_f32_16x16x32_bf16 a[68:71], a[0:3], v[124:127], a[68:71]
    s_waitcnt vmcnt(3)
    v_mfma_f32_16x16x32_bf16 a[80:83], a[4:7], v[124:127], a[80:83]
    s_waitcnt vmcnt(2)
    v_mfma_f32_16x16x32_bf16 a[92:95], a[8:11], v[124:127], a[92:95]
    s_waitcnt vmcnt(1)
    v_mfma_f32_16x16x32_bf16 a[104:107], a[12:15], v[124:127], a[104:107]
    s_waitcnt vmcnt(0)
    v_mfma_f32_16x16x32_bf16 a[116:119], a[64:67], v[124:127], a[116:119]
    v_mfma_f32_16x16x32_bf16 v[84:87], a[0:3], v[120:123], v[84:87]
    v_mfma_f32_16x16x32_bf16 v[88:91], a[4:7], v[120:123], v[88:91]
    v_mfma_f32_16x16x32_bf16 v[92:95], a[8:11], v[120:123], v[92:95]
    v_mfma_f32_16x16x32_bf16 v[96:99], a[12:15], v[120:123], v[96:99]
    v_mfma_f32_16x16x32_bf16 v[100:103], a[64:67], v[120:123], v[100:103]
    ds_write_b128 v20, a[68:71] offset:0
    ds_write_b128 v20, a[80:83] offset:1024
    ds_write_b128 v20, a[92:95] offset:2048
    ds_write_b128 v20, a[104:107] offset:3072
    ds_write_b128 v20, a[116:119] offset:4096
    s_waitcnt lgkmcnt(0)
    s_barrier
    ds_read_b128 v[24:27], v21 offset:0
    ds_read_b128 v[28:31], v22 offset:0
    ds_read_b128 v[32:35], v23 offset:0
    ds_read_b128 v[36:39], v21 offset:1024
    ds_read_b128 v[40:43], v22 offset:1024
    ds_read_b128 v[44:47], v23 offset:1024
    ds_read_b128 v[48:51], v21 offset:2048
    ds_read_b128 v[52:55], v22 offset:2048
    ds_read_b128 v[56:59], v23 offset:2048
    ds_read_b128 v[60:63], v21 offset:3072
    ds_read_b128 v[64:67], v22 offset:3072
    ds_read_b128 v[68:71], v23 offset:3072
    ds_read_b128 v[72:75], v21 offset:4096
    ds_read_b128 v[76:79], v22 offset:4096
    ds_read_b128 v[80:83], v23 offset:4096
    s_waitcnt lgkmcnt(12)
    v_pk_add_f32 v[24:25], v[24:25], v[28:29]
    v_pk_add_f32 v[84:85], v[84:85], v[32:33]
    v_pk_add_f32 v[26:27], v[26:27], v[30:31]
    v_pk_add_f32 v[86:87], v[86:87], v[34:35]
    v_pk_add_f32 v[84:85], v[84:85], v[24:25]
    v_pk_add_f32 v[86:87], v[86:87], v[26:27]
    v_cvt_pk_bf16_f32 v104, v84, v85
    v_cvt_pk_bf16_f32 v105, v86, v87
    s_waitcnt lgkmcnt(9)
    v_pk_add_f32 v[36:37], v[36:37], v[40:41]
    v_pk_add_f32 v[88:89], v[88:89], v[44:45]
    v_pk_add_f32 v[38:39], v[38:39], v[42:43]
    v_pk_add_f32 v[90:91], v[90:91], v[46:47]
    v_pk_add_f32 v[88:89], v[88:89], v[36:37]
    v_pk_add_f32 v[90:91], v[90:91], v[38:39]
    v_cvt_pk_bf16_f32 v106, v88, v89
    v_cvt_pk_bf16_f32 v107, v90, v91
    s_nop 0
    v_permlane16_swap_b32 v104, v106
    v_permlane16_swap_b32 v105, v107
    buffer_store_dwordx4 v[104:107], v116, s[64:67], s94 offen offset:0
    s_waitcnt lgkmcnt(6)
    v_pk_add_f32 v[48:49], v[48:49], v[52:53]
    v_pk_add_f32 v[92:93], v[92:93], v[56:57]
    v_pk_add_f32 v[50:51], v[50:51], v[54:55]
    v_pk_add_f32 v[94:95], v[94:95], v[58:59]
    v_pk_add_f32 v[92:93], v[92:93], v[48:49]
    v_pk_add_f32 v[94:95], v[94:95], v[50:51]
    v_cvt_pk_bf16_f32 v108, v92, v93
    v_cvt_pk_bf16_f32 v109, v94, v95
    s_waitcnt lgkmcnt(3)
    v_pk_add_f32 v[60:61], v[60:61], v[64:65]
    v_pk_add_f32 v[96:97], v[96:97], v[68:69]
    v_pk_add_f32 v[62:63], v[62:63], v[66:67]
    v_pk_add_f32 v[98:99], v[98:99], v[70:71]
    v_pk_add_f32 v[96:97], v[96:97], v[60:61]
    v_pk_add_f32 v[98:99], v[98:99], v[62:63]
    v_cvt_pk_bf16_f32 v110, v96, v97
    v_cvt_pk_bf16_f32 v111, v98, v99
    s_nop 0
    v_permlane16_swap_b32 v108, v110
    v_permlane16_swap_b32 v109, v111
    buffer_store_dwordx4 v[108:111], v116, s[64:67], s94 offen offset:64
    s_waitcnt lgkmcnt(0)
    v_pk_add_f32 v[72:73], v[72:73], v[76:77]
    v_pk_add_f32 v[100:101], v[100:101], v[80:81]
    v_pk_add_f32 v[74:75], v[74:75], v[78:79]
    v_pk_add_f32 v[102:103], v[102:103], v[82:83]
    v_pk_add_f32 v[100:101], v[100:101], v[72:73]
    v_pk_add_f32 v[102:103], v[102:103], v[74:75]
    v_cvt_pk_bf16_f32 v112, v100, v101
    v_cvt_pk_bf16_f32 v113, v102, v103
    buffer_store_dwordx2 v[112:113], v18, s[64:67], s94 offen offset:128
    s_or_b32 s51, s2, s3
    s_cmp_lg_u32 s51, 0
    s_cbranch_scc1 L_noep
    s_mov_b64 exec, 1
    buffer_store_dword v9, v10, s[68:71], 0 offen
    s_mov_b64 exec, -1
L_noep:
    s_endpgm
L_aux:
    s_cmp_eq_u32 s3, 7
    s_cbranch_scc1 L_serv
    s_setprio 0
    s_mul_i32 s77, s14, 14976
    s_add_u32 s77, s77, 0
    s_waitcnt lgkmcnt(0)
    s_and_b32 s51, s13, 1
    s_lshl_b32 s51, s51, 4
    s_lshr_b32 s80, s80, s51
    s_lshl_b32 s80, s80, 16
    s_lshr_b32 s81, s81, s51
    s_lshl_b32 s81, s81, 16
    v_mov_b32 v62, s80
    v_mov_b32 v63, 0x3fb8aa3b
    v_mul_f32 v64, v62, v63
    v_fma_f32 v65, v62, v63, -v64
    v_fmac_f32 v65, 0x32a57060, v62
    v_exp_f32 v64, v64
    v_mul_f32 v65, 0x3f317218, v65
    v_fma_f32 v54, v64, v65, v64
    v_cvt_pk_bf16_f32 v54, v54, v54
    v_lshlrev_b32 v54, 16, v54
    v_mul_f32 v55, 0x3fb8aa3b, v54
    v_mul_f32 v56, 0.15915494, v54
    v_cmp_eq_u32 vcc, 0, v1
    v_mov_b32 v62, s81
    s_nop 0
    v_cndmask_b32 v57, 0, v62, vcc
    s_mov_b32 m0, s77
    v_and_b32 v62, 31, v1
    v_lshrrev_b32 v63, 5, v1
    v_lshlrev_b32 v63, 4, v63
    v_add_u32 v63, s77, v63
    v_mul_u32_u24 v64, 272, v62
    v_add_u32 v60, v64, v63
    v_min_u32 v62, 20, v62
    v_mul_u32_u24 v64, 272, v62
    v_add_u32 v59, v64, v63
    v_mov_b32 v28, 0x3f80
    v_and_b32 v62, 31, v1
    v_lshrrev_b32 v63, 5, v1
    s_add_u32 s51, s77, 32
    v_lshlrev_b32 v64, 4, v62
    v_lshl_add_u32 v64, v63, 3, v64
    v_add_u32 v64, s51, v64
    v_cmp_eq_u32 vcc, 0, v63
    v_lshlrev_b32 v65, 3, v62
    v_add_u32 v65, 512, v65
    v_lshlrev_b32 v66, 2, v62
    v_add_u32 v66, 768, v66
    v_cndmask_b32 v65, v66, v65, vcc
    v_add_u32 v65, s51, v65
    v_mov_b32 v66, 128
    v_cndmask_b32 v66, v66, 4, vcc
    v_add_u32 v66, v65, v66
    v_lshlrev_b32 v67, 1, v62
    v_lshl_add_u32 v67, v63, 8, v67
    v_add_u32 v67, s51, v67
    s_add_u32 s51, s77, 0
    v_mul_u32_u24 v100, 16, v1
    v_add_u32 v100, s51, v100
    s_add_u32 s51, s77, 1232
    v_sub_u32 v101, s51, v2
    s_add_u32 s51, s77, 544
    v_mul_u32_u24 v102, 8, v1
    v_add_u32 v102, s51, v102
    s_add_u32 s51, s77, 688
    v_sub_u32 v103, s51, v2
    v_cmp_gt_u32 vcc, 16, v1
    v_mov_b32 v104, 563
    v_mov_b32 v105, 512
    v_cndmask_b32 v104, v104, v105, vcc
    v_add_u32 v104, v104, v1
    v_mov_b32 v106, 1011
    v_cndmask_b32 v105, v106, v105, vcc
    v_add_u32 v105, v105, v1
    v_cvt_f32_u32 v105, v105
    v_cvt_pk_bf16_f32 v105, v105, v105
    v_and_b32 v105, 0xffff, v105
    s_sub_u32 s51, s77, 34016
    v_lshl_add_u32 v105, v105, 1, s51
    s_add_u32 s51, s77, 1214
    v_lshlrev_b32 v104, 1, v104
    v_sub_u32 v104, s51, v104
    v_add_u32 v107, 1, v1
    v_and_b32 v107, 0x7e, v107
    s_add_u32 s51, s77, 4096
    v_sub_u32 v107, s51, v107
    v_and_b32 v106, 1, v1
    v_mul_u32_u24 v108, 192, v106
    v_add_u32 v108, v107, v108
    v_mul_u32_u24 v106, 272, v106
    v_add_u32 v107, v107, v106
    v_lshl_add_u32 v106, v1, 1, s77
    v_lshrrev_b32 v32, 4, v1
    v_and_b32 v31, 15, v1
    v_bfe_u32 v33, v1, 1, 3
    v_lshlrev_b32 v34, 2, v32
    v_sub_u32 v34, v34, v33
    v_and_b32 v33, 1, v1
    v_xor_b32 v33, 1, v33
    v_mul_u32_u24 v33, 337, v33
    v_add_u32 v34, v34, v33
    s_add_u32 s51, s77, 1436
    v_lshl_add_u32 v44, v34, 2, s51
    v_add_u32 v45, 512, v44
    v_lshlrev_b32 v33, 3, v32
    v_lshlrev_b32 v34, 2, v31
    v_sub_u32 v46, v33, v34
    s_add_u32 s51, s77, 4156
    v_add_u32 v46, s51, v46
    v_lshlrev_b32 v34, 1, v31
    v_sub_u32 v47, v33, v34
    v_and_b32 v34, 1, v31
    v_mul_u32_u24 v34, 386, v34
    v_sub_u32 v47, v47, v34
    s_add_u32 s51, s77, 5088
    v_add_u32 v47, s51, v47
    v_lshl_add_u32 v34, v31, 1, v32
    s_add_u32 s51, s77, 10400
    v_lshl_add_u32 v40, v34, 4, s51
    v_add_u32 v34, v31, v32
    s_add_u32 s51, s77, 10832
    v_lshl_add_u32 v41, v34, 4, s51
    v_and_b32 v34, 1, v32
    v_lshlrev_b32 v34, 9, v34
    v_lshl_add_u32 v34, v31, 5, v34
    v_lshrrev_b32 v32, 1, v32
    v_lshl_add_u32 v42, v32, 4, v34
    s_lshl_b32 s86, s13, 12
    s_add_u32 s86, s86, 5111808
    s_mul_i32 s89, s6, 24
    s_add_u32 s89, s89, s7
    s_lshl_b32 s89, s89, 7
    s_add_u32 s89, s89, 360448
    s_sub_u32 s88, s99, 1
    v_accvgpr_write_b32 a80, v64
    v_accvgpr_write_b32 a81, v65
    v_accvgpr_write_b32 a82, v66
    v_accvgpr_write_b32 a83, v67
    v_accvgpr_write_b32 a84, v100
    v_accvgpr_write_b32 a85, v101
    v_accvgpr_write_b32 a86, v102
    v_accvgpr_write_b32 a87, v103
    v_accvgpr_write_b32 a88, v104
    v_accvgpr_write_b32 a89, v105
    v_accvgpr_write_b32 a90, v106
    v_accvgpr_write_b32 a91, v107
    v_accvgpr_write_b32 a92, v108
    v_accvgpr_write_b32 a93, v44
    v_accvgpr_write_b32 a94, v45
    v_accvgpr_write_b32 a95, v46
    v_accvgpr_write_b32 a96, v47
    v_accvgpr_write_b32 a97, v40
    v_accvgpr_write_b32 a98, v41
    v_accvgpr_write_b32 a99, v42
    s_waitcnt vmcnt(0)
    s_mov_b32 s76, 0
L_kg:
    v_lshlrev_b32 v62, 16, v4
    v_alignbit_b32 v4, v5, v4, 16
    v_lshlrev_b32 v63, 16, v6
    v_alignbit_b32 v6, v7, v6, 16
    v_lshlrev_b32 v64, 16, v8
    v_alignbit_b32 v8, v12, v8, 16
    v_lshlrev_b32 v65, 16, v13
    v_alignbit_b32 v13, v14, v13, 16
    v_lshlrev_b32 v66, 16, v15
    v_alignbit_b32 v15, v16, v15, 16
    v_lshlrev_b32 v67, 16, v17
    v_alignbit_b32 v17, v18, v17, 16
    v_mul_f32 v68, v62, v55
    v_mul_f32 v69, v63, v56
    v_mul_f32 v64, v64, v54
    v_mul_f32 v65, v65, v54
    v_mov_b32 v76, v68
    v_fract_f32 v79, v69
    v_mul_f32 v77, 0x41000000, v68
    v_mul_f32 v80, 0x41000000, v69
    v_fract_f32 v80, v80
    v_mul_f32 v78, 0x43800000, v68
    v_mul_f32 v81, 0x43800000, v69
    v_fract_f32 v81, v81
    v_pk_mul_f32 v[82:83], v[66:67], v[64:65] op_sel_hi:[0,1]
    v_pk_fma_f32 v[82:83], v[66:67], v[64:65], v[82:83] op_sel:[1,1,0] op_sel_hi:[1,0,1] neg_lo:[1,0,0]
    v_exp_f32 v76, v76
    v_cos_f32 v70, v79
    v_sin_f32 v71, v79
    v_exp_f32 v77, v77
    v_cos_f32 v72, v80
    v_sin_f32 v73, v80
    v_exp_f32 v78, v78
    v_cos_f32 v74, v81
    v_sin_f32 v75, v81
    v_mul_f32 v70, v70, v76
    v_mul_f32 v71, v71, v76
    v_mul_f32 v72, v72, v77
    v_mul_f32 v73, v73, v77
    v_mul_f32 v74, v74, v78
    v_mul_f32 v75, v75, v78
    v_pk_mul_f32 v[98:99], v[70:71], v[70:71] op_sel_hi:[0,1]
    v_pk_mul_f32 v[102:103], v[72:73], v[72:73] op_sel_hi:[0,1]
    v_pk_mul_f32 v[104:105], v[74:75], v[74:75] op_sel_hi:[0,1]
    v_pk_mul_f32 v[84:85], v[82:83], v[70:71] op_sel_hi:[0,1]
    v_pk_fma_f32 v[98:99], v[70:71], v[70:71], v[98:99] op_sel:[1,1,0] op_sel_hi:[1,0,1] neg_lo:[1,0,0]
    v_pk_fma_f32 v[102:103], v[72:73], v[72:73], v[102:103] op_sel:[1,1,0] op_sel_hi:[1,0,1] neg_lo:[1,0,0]
    v_pk_fma_f32 v[104:105], v[74:75], v[74:75], v[104:105] op_sel:[1,1,0] op_sel_hi:[1,0,1] neg_lo:[1,0,0]
    v_pk_fma_f32 v[84:85], v[82:83], v[70:71], v[84:85] op_sel:[1,1,0] op_sel_hi:[1,0,1] neg_lo:[1,0,0]
    v_pk_mul_f32 v[100:101], v[98:99], v[98:99] op_sel_hi:[0,1]
    v_pk_mul_f32 v[112:113], v[102:103], v[72:73] op_sel_hi:[0,1]
    v_pk_mul_f32 v[114:115], v[102:103], v[102:103] op_sel_hi:[0,1]
    v_pk_mul_f32 v[86:87], v[82:83], v[98:99] op_sel_hi:[0,1]
    v_pk_mul_f32 v[88:89], v[84:85], v[98:99] op_sel_hi:[0,1]
    v_pk_fma_f32 v[100:101], v[98:99], v[98:99], v[100:101] op_sel:[1,1,0] op_sel_hi:[1,0,1] neg_lo:[1,0,0]
    v_pk_fma_f32 v[112:113], v[102:103], v[72:73], v[112:113] op_sel:[1,1,0] op_sel_hi:[1,0,1] neg_lo:[1,0,0]
    v_pk_fma_f32 v[114:115], v[102:103], v[102:103], v[114:115] op_sel:[1,1,0] op_sel_hi:[1,0,1] neg_lo:[1,0,0]
    v_pk_fma_f32 v[86:87], v[82:83], v[98:99], v[86:87] op_sel:[1,1,0] op_sel_hi:[1,0,1] neg_lo:[1,0,0]
    v_pk_fma_f32 v[88:89], v[84:85], v[98:99], v[88:89] op_sel:[1,1,0] op_sel_hi:[1,0,1] neg_lo:[1,0,0]
    s_waitcnt lgkmcnt(0)
    ds_write_addtid_b32 v28
    v_mfma_f32_32x32x16_bf16 a[0:15], a[16:19], a[48:51], a[0:15]
    v_cvt_pk_bf16_f32 v116, v72, v73
    v_cvt_pk_bf16_f32 v117, v102, v103
    v_cvt_pk_bf16_f32 v118, v112, v113
    v_cvt_pk_bf16_f32 v119, v114, v115
    ds_write_addtid_b32 v116 offset:272
    ds_write_addtid_b32 v117 offset:544
    ds_write_addtid_b32 v118 offset:816
    ds_write_addtid_b32 v119 offset:1088
    v_pk_mul_f32 v[20:21], v[72:73], v[114:115] op_sel_hi:[0,1]
    v_pk_mul_f32 v[22:23], v[102:103], v[114:115] op_sel_hi:[0,1]
    v_pk_mul_f32 v[24:25], v[112:113], v[114:115] op_sel_hi:[0,1]
    v_pk_mul_f32 v[26:27], v[114:115], v[114:115] op_sel_hi:[0,1]
    v_pk_fma_f32 v[20:21], v[72:73], v[114:115], v[20:21] op_sel:[1,1,0] op_sel_hi:[1,0,1] neg_lo:[1,0,0]
    v_pk_fma_f32 v[22:23], v[102:103], v[114:115], v[22:23] op_sel:[1,1,0] op_sel_hi:[1,0,1] neg_lo:[1,0,0]
    v_pk_fma_f32 v[24:25], v[112:113], v[114:115], v[24:25] op_sel:[1,1,0] op_sel_hi:[1,0,1] neg_lo:[1,0,0]
    v_pk_fma_f32 v[26:27], v[114:115], v[114:115], v[26:27] op_sel:[1,1,0] op_sel_hi:[1,0,1] neg_lo:[1,0,0]
    v_pk_mul_f32 v[106:107], v[20:21], v[114:115] op_sel_hi:[0,1]
    v_pk_mul_f32 v[108:109], v[22:23], v[114:115] op_sel_hi:[0,1]
    v_pk_mul_f32 v[110:111], v[24:25], v[114:115] op_sel_hi:[0,1]
    v_pk_mul_f32 v[112:113], v[26:27], v[114:115] op_sel_hi:[0,1]
    v_pk_fma_f32 v[106:107], v[20:21], v[114:115], v[106:107] op_sel:[1,1,0] op_sel_hi:[1,0,1] neg_lo:[1,0,0]
    v_pk_fma_f32 v[108:109], v[22:23], v[114:115], v[108:109] op_sel:[1,1,0] op_sel_hi:[1,0,1] neg_lo:[1,0,0]
    v_pk_fma_f32 v[110:111], v[24:25], v[114:115], v[110:111] op_sel:[1,1,0] op_sel_hi:[1,0,1] neg_lo:[1,0,0]
    v_pk_fma_f32 v[112:113], v[26:27], v[114:115], v[112:113] op_sel:[1,1,0] op_sel_hi:[1,0,1] neg_lo:[1,0,0]
    v_mfma_f32_32x32x16_bf16 a[0:15], a[20:23], a[52:55], a[0:15]
    v_cvt_pk_bf16_f32 v120, v20, v21
    v_cvt_pk_bf16_f32 v121, v22, v23
    v_cvt_pk_bf16_f32 v122, v24, v25
    v_cvt_pk_bf16_f32 v123, v26, v27
    ds_write_addtid_b32 v120 offset:1360
    ds_write_addtid_b32 v121 offset:1632
    ds_write_addtid_b32 v122 offset:1904
    ds_write_addtid_b32 v123 offset:2176
    v_pk_mul_f32 v[90:91], v[82:83], v[100:101] op_sel_hi:[0,1]
    v_pk_mul_f32 v[92:93], v[84:85], v[100:101] op_sel_hi:[0,1]
    v_pk_mul_f32 v[94:95], v[86:87], v[100:101] op_sel_hi:[0,1]
    v_pk_mul_f32 v[96:97], v[88:89], v[100:101] op_sel_hi:[0,1]
    v_pk_fma_f32 v[90:91], v[82:83], v[100:101], v[90:91] op_sel:[1,1,0] op_sel_hi:[1,0,1] neg_lo:[1,0,0]
    v_pk_fma_f32 v[92:93], v[84:85], v[100:101], v[92:93] op_sel:[1,1,0] op_sel_hi:[1,0,1] neg_lo:[1,0,0]
    v_pk_fma_f32 v[94:95], v[86:87], v[100:101], v[94:95] op_sel:[1,1,0] op_sel_hi:[1,0,1] neg_lo:[1,0,0]
    v_pk_fma_f32 v[96:97], v[88:89], v[100:101], v[96:97] op_sel:[1,1,0] op_sel_hi:[1,0,1] neg_lo:[1,0,0]
    v_pk_mul_f32 v[20:21], v[106:107], v[114:115] op_sel_hi:[0,1]
    v_pk_mul_f32 v[22:23], v[108:109], v[114:115] op_sel_hi:[0,1]
    v_pk_mul_f32 v[24:25], v[110:111], v[114:115] op_sel_hi:[0,1]
    v_pk_mul_f32 v[26:27], v[112:113], v[114:115] op_sel_hi:[0,1]
    v_pk_fma_f32 v[20:21], v[106:107], v[114:115], v[20:21] op_sel:[1,1,0] op_sel_hi:[1,0,1] neg_lo:[1,0,0]
    v_pk_fma_f32 v[22:23], v[108:109], v[114:115], v[22:23] op_sel:[1,1,0] op_sel_hi:[1,0,1] neg_lo:[1,0,0]
    v_pk_fma_f32 v[24:25], v[110:111], v[114:115], v[24:25] op_sel:[1,1,0] op_sel_hi:[1,0,1] neg_lo:[1,0,0]
    v_pk_fma_f32 v[26:27], v[112:113], v[114:115], v[26:27] op_sel:[1,1,0] op_sel_hi:[1,0,1] neg_lo:[1,0,0]
    v_mfma_f32_32x32x16_bf16 a[0:15], a[24:27], a[56:59], a[0:15]
    v_cvt_pk_bf16_f32 v116, v106, v107
    v_cvt_pk_bf16_f32 v117, v108, v109
    v_cvt_pk_bf16_f32 v118, v110, v111
    v_cvt_pk_bf16_f32 v119, v112, v113
    ds_write_addtid_b32 v116 offset:2448
    ds_write_addtid_b32 v117 offset:2720
    ds_write_addtid_b32 v118 offset:2992
    ds_write_addtid_b32 v119 offset:3264
    v_pk_mul_f32 v[30:31], v[82:83], v[74:75] op_sel_hi:[0,1]
    v_pk_mul_f32 v[32:33], v[86:87], v[74:75] op_sel_hi:[0,1]
    v_pk_mul_f32 v[34:35], v[90:91], v[74:75] op_sel_hi:[0,1]
    v_pk_mul_f32 v[36:37], v[94:95], v[74:75] op_sel_hi:[0,1]
    v_pk_fma_f32 v[30:31], v[82:83], v[74:75], v[30:31] op_sel:[1,1,0] op_sel_hi:[1,0,1] neg_lo:[1,0,0]
    v_pk_fma_f32 v[32:33], v[86:87], v[74:75], v[32:33] op_sel:[1,1,0] op_sel_hi:[1,0,1] neg_lo:[1,0,0]
    v_pk_fma_f32 v[34:35], v[90:91], v[74:75], v[34:35] op_sel:[1,1,0] op_sel_hi:[1,0,1] neg_lo:[1,0,0]
    v_pk_fma_f32 v[36:37], v[94:95], v[74:75], v[36:37] op_sel:[1,1,0] op_sel_hi:[1,0,1] neg_lo:[1,0,0]
    v_pk_mul_f32 v[106:107], v[20:21], v[114:115] op_sel_hi:[0,1]
    v_pk_mul_f32 v[108:109], v[22:23], v[114:115] op_sel_hi:[0,1]
    v_pk_mul_f32 v[110:111], v[24:25], v[114:115] op_sel_hi:[0,1]
    v_pk_mul_f32 v[112:113], v[26:27], v[114:115] op_sel_hi:[0,1]
    v_pk_fma_f32 v[106:107], v[20:21], v[114:115], v[106:107] op_sel:[1,1,0] op_sel_hi:[1,0,1] neg_lo:[1,0,0]
    v_pk_fma_f32 v[108:109], v[22:23], v[114:115], v[108:109] op_sel:[1,1,0] op_sel_hi:[1,0,1] neg_lo:[1,0,0]
    v_pk_fma_f32 v[110:111], v[24:25], v[114:115], v[110:111] op_sel:[1,1,0] op_sel_hi:[1,0,1] neg_lo:[1,0,0]
    v_pk_fma_f32 v[112:113], v[26:27], v[114:115], v[112:113] op_sel:[1,1,0] op_sel_hi:[1,0,1] neg_lo:[1,0,0]
    v_mfma_f32_32x32x16_bf16 a[0:15], a[28:31], a[60:63], a[0:15]
    v_cvt_pk_bf16_f32 v120, v20, v21
    v_cvt_pk_bf16_f32 v121, v22, v23
    v_cvt_pk_bf16_f32 v122, v24, v25
    v_cvt_pk_bf16_f32 v123, v26, v27
    ds_write_addtid_b32 v120 offset:3536
    ds_write_addtid_b32 v121 offset:3808
    ds_write_addtid_b32 v122 offset:4080
    ds_write_addtid_b32 v123 offset:4352
    v_pk_mul_f32 v[38:39], v[82:83], v[104:105] op_sel_hi:[0,1]
    v_pk_mul_f32 v[40:41], v[90:91], v[104:105] op_sel_hi:[0,1]
    v_pk_mul_f32 v[42:43], v[30:31], v[104:105] op_sel_hi:[0,1]
    v_pk_mul_f32 v[44:45], v[34:35], v[104:105] op_sel_hi:[0,1]
    v_pk_fma_f32 v[38:39], v[82:83], v[104:105], v[38:39] op_sel:[1,1,0] op_sel_hi:[1,0,1] neg_lo:[1,0,0]
    v_pk_fma_f32 v[40:41], v[90:91], v[104:105], v[40:41] op_sel:[1,1,0] op_sel_hi:[1,0,1] neg_lo:[1,0,0]
    v_pk_fma_f32 v[42:43], v[30:31], v[104:105], v[42:43] op_sel:[1,1,0] op_sel_hi:[1,0,1] neg_lo:[1,0,0]
    v_pk_fma_f32 v[44:45], v[34:35], v[104:105], v[44:45] op_sel:[1,1,0] op_sel_hi:[1,0,1] neg_lo:[1,0,0]
    v_pk_mul_f32 v[20:21], v[106:107], v[114:115] op_sel_hi:[0,1]
    v_pk_mul_f32 v[22:23], v[108:109], v[114:115] op_sel_hi:[0,1]
    v_pk_mul_f32 v[24:25], v[110:111], v[114:115] op_sel_hi:[0,1]
    v_pk_mul_f32 v[26:27], v[112:113], v[114:115] op_sel_hi:[0,1]
    v_pk_fma_f32 v[20:21], v[106:107], v[114:115], v[20:21] op_sel:[1,1,0] op_sel_hi:[1,0,1] neg_lo:[1,0,0]
    v_pk_fma_f32 v[22:23], v[108:109], v[114:115], v[22:23] op_sel:[1,1,0] op_sel_hi:[1,0,1] neg_lo:[1,0,0]
    v_pk_fma_f32 v[24:25], v[110:111], v[114:115], v[24:25] op_sel:[1,1,0] op_sel_hi:[1,0,1] neg_lo:[1,0,0]
    v_pk_fma_f32 v[26:27], v[112:113], v[114:115], v[26:27] op_sel:[1,1,0] op_sel_hi:[1,0,1] neg_lo:[1,0,0]
    v_mfma_f32_32x32x16_bf16 a[0:15], a[32:35], a[64:67], a[0:15]
    v_cvt_pk_bf16_f32 v116, v106, v107
    v_cvt_pk_bf16_f32 v117, v108, v109
    v_cvt_pk_bf16_f32 v118, v110, v111
    v_cvt_pk_bf16_f32 v119, v112, v113
    ds_write_addtid_b32 v116 offset:4624
    ds_write_addtid_b32 v117 offset:4896
    ds_write_addtid_b32 v118 offset:5168
    ds_write_addtid_b32 v119 offset:5440
    v_pk_mul_f32 v[46:47], v[38:39], v[104:105] op_sel_hi:[0,1]
    v_pk_mul_f32 v[48:49], v[42:43], v[104:105] op_sel_hi:[0,1]
    v_pk_fma_f32 v[46:47], v[38:39], v[104:105], v[46:47] op_sel:[1,1,0] op_sel_hi:[1,0,1] neg_lo:[1,0,0]
    v_pk_fma_f32 v[48:49], v[42:43], v[104:105], v[48:49] op_sel:[1,1,0] op_sel_hi:[1,0,1] neg_lo:[1,0,0]
    v_pk_mul_f32 v[106:107], v[20:21], v[114:115] op_sel_hi:[0,1]
    v_pk_mul_f32 v[108:109], v[22:23], v[114:115] op_sel_hi:[0,1]
    v_pk_mul_f32 v[110:111], v[24:25], v[114:115] op_sel_hi:[0,1]
    v_pk_mul_f32 v[112:113], v[26:27], v[114:115] op_sel_hi:[0,1]
    v_pk_fma_f32 v[106:107], v[20:21], v[114:115], v[106:107] op_sel:[1,1,0] op_sel_hi:[1,0,1] neg_lo:[1,0,0]
    v_pk_fma_f32 v[108:109], v[22:23], v[114:115], v[108:109] op_sel:[1,1,0] op_sel_hi:[1,0,1] neg_lo:[1,0,0]
    v_pk_fma_f32 v[110:111], v[24:25], v[114:115], v[110:111] op_sel:[1,1,0] op_sel_hi:[1,0,1] neg_lo:[1,0,0]
    v_pk_fma_f32 v[112:113], v[26:27], v[114:115], v[112:113] op_sel:[1,1,0] op_sel_hi:[1,0,1] neg_lo:[1,0,0]
    v_mfma_f32_32x32x16_bf16 a[0:15], a[36:39], a[68:71], a[0:15]
    v_cvt_pk_bf16_f32 v120, v20, v21
    v_cvt_pk_bf16_f32 v121, v22, v23
    v_cvt_pk_bf16_f32 v122, v24, v25
    v_cvt_pk_bf16_f32 v123, v26, v27
    ds_write_addtid_b32 v120 offset:5712
    ds_write_addtid_b32 v121 offset:5984
    ds_write_addtid_b32 v122 offset:6256
    ds_write_addtid_b32 v123 offset:6528
    v_pk_mul_f32 v[50:51], v[46:47], v[104:105] op_sel_hi:[0,1]
    v_pk_mul_f32 v[52:53], v[48:49], v[104:105] op_sel_hi:[0,1]
    v_pk_fma_f32 v[50:51], v[46:47], v[104:105], v[50:51] op_sel:[1,1,0] op_sel_hi:[1,0,1] neg_lo:[1,0,0]
    v_pk_fma_f32 v[52:53], v[48:49], v[104:105], v[52:53] op_sel:[1,1,0] op_sel_hi:[1,0,1] neg_lo:[1,0,0]
    v_pk_mul_f32 v[20:21], v[106:107], v[114:115] op_sel_hi:[0,1]
    v_pk_mul_f32 v[22:23], v[108:109], v[114:115] op_sel_hi:[0,1]
    v_pk_mul_f32 v[24:25], v[110:111], v[114:115] op_sel_hi:[0,1]
    v_pk_fma_f32 v[20:21], v[106:107], v[114:115], v[20:21] op_sel:[1,1,0] op_sel_hi:[1,0,1] neg_lo:[1,0,0]
    v_pk_fma_f32 v[22:23], v[108:109], v[114:115], v[22:23] op_sel:[1,1,0] op_sel_hi:[1,0,1] neg_lo:[1,0,0]
    v_pk_fma_f32 v[24:25], v[110:111], v[114:115], v[24:25] op_sel:[1,1,0] op_sel_hi:[1,0,1] neg_lo:[1,0,0]
    v_mfma_f32_32x32x16_bf16 a[0:15], a[40:43], a[72:75], a[0:15]
    v_cvt_pk_bf16_f32 v116, v106, v107
    v_cvt_pk_bf16_f32 v117, v108, v109
    v_cvt_pk_bf16_f32 v118, v110, v111
    v_cvt_pk_bf16_f32 v119, v112, v113
    ds_write_addtid_b32 v116 offset:6800
    ds_write_addtid_b32 v117 offset:7072
    ds_write_addtid_b32 v118 offset:7344
    ds_write_addtid_b32 v119 offset:7616
    v_pk_mul_f32 v[70:71], v[50:51], v[104:105] op_sel_hi:[0,1]
    v_pk_fma_f32 v[70:71], v[50:51], v[104:105], v[70:71] op_sel:[1,1,0] op_sel_hi:[1,0,1] neg_lo:[1,0,0]
    v_mfma_f32_32x32x16_bf16 a[0:15], a[44:47], a[76:79], a[0:15]
    v_cvt_pk_bf16_f32 v120, v20, v21
    v_cvt_pk_bf16_f32 v121, v22, v23
    v_cvt_pk_bf16_f32 v122, v24, v25
    ds_write_addtid_b32 v120 offset:7888
    ds_write_addtid_b32 v121 offset:8160
    ds_write_addtid_b32 v122 offset:8432
    ds_read_b128 a[48:51], v60 offset:0
    ds_read_b128 a[52:55], v60 offset:32
    ds_read_b128 a[56:59], v60 offset:64
    ds_read_b128 a[60:63], v60 offset:96
    ds_read_b128 a[64:67], v60 offset:128
    ds_read_b128 a[68:71], v60 offset:160
    ds_read_b128 a[72:75], v60 offset:192
    ds_read_b128 a[76:79], v60 offset:224
    v_cvt_pk_bf16_f32 v123, v82, -v83
    v_cvt_pk_bf16_f32 v116, v84, -v85
    v_cvt_pk_bf16_f32 v117, v86, -v87
    v_cvt_pk_bf16_f32 v118, v88, -v89
    ds_write_addtid_b32 v123 offset:0
    ds_write_addtid_b32 v116 offset:272
    ds_write_addtid_b32 v117 offset:544
    ds_write_addtid_b32 v118 offset:816
    v_cvt_pk_bf16_f32 v119, v90, -v91
    v_cvt_pk_bf16_f32 v120, v92, -v93
    v_cvt_pk_bf16_f32 v121, v94, -v95
    v_cvt_pk_bf16_f32 v122, v96, -v97
    ds_write_addtid_b32 v119 offset:1088
    ds_write_addtid_b32 v120 offset:1360
    ds_write_addtid_b32 v121 offset:1632
    ds_write_addtid_b32 v122 offset:1904
    v_cvt_pk_bf16_f32 v123, v30, -v31
    v_cvt_pk_bf16_f32 v116, v32, -v33
    v_cvt_pk_bf16_f32 v117, v34, -v35
    v_cvt_pk_bf16_f32 v118, v36, -v37
    ds_write_addtid_b32 v123 offset:2176
    ds_write_addtid_b32 v116 offset:2448
    ds_write_addtid_b32 v117 offset:2720
    ds_write_addtid_b32 v118 offset:2992
    v_cvt_pk_bf16_f32 v119, v38, -v39
    v_cvt_pk_bf16_f32 v120, v40, -v41
    v_cvt_pk_bf16_f32 v121, v42, -v43
    v_cvt_pk_bf16_f32 v122, v44, -v45
    ds_write_addtid_b32 v119 offset:3264
    ds_write_addtid_b32 v120 offset:3536
    ds_write_addtid_b32 v121 offset:3808
    ds_write_addtid_b32 v122 offset:4080
    v_cvt_pk_bf16_f32 v123, v46, -v47
    v_cvt_pk_bf16_f32 v116, v48, -v49
    v_cvt_pk_bf16_f32 v117, v50, -v51
    v_cvt_pk_bf16_f32 v118, v52, -v53
    v_cvt_pk_bf16_f32 v119, v70, -v71
    ds_write_addtid_b32 v123 offset:4352
    ds_write_addtid_b32 v116 offset:4624
    ds_write_addtid_b32 v117 offset:4896
    ds_write_addtid_b32 v118 offset:5168
    ds_write_addtid_b32 v119 offset:5440
    ds_read_b128 a[16:19], v59 offset:0
    ds_read_b128 a[20:23], v59 offset:32
    ds_read_b128 a[24:27], v59 offset:64
    ds_read_b128 a[28:31], v59 offset:96
    ds_read_b128 a[32:35], v59 offset:128
    ds_read_b128 a[36:39], v59 offset:160
    ds_read_b128 a[40:43], v59 offset:192
    ds_read_b128 a[44:47], v59 offset:224
    s_cmp_lg_u32 s76, 0
    s_cbranch_scc1 L_kg1
    v_accvgpr_write_b32 a0, 0
    v_accvgpr_write_b32 a1, 0
    v_accvgpr_write_b32 a2, 0
    v_accvgpr_write_b32 a3, 0
    v_accvgpr_write_b32 a4, 0
    v_accvgpr_write_b32 a5, 0
    v_accvgpr_write_b32 a6, 0
    v_accvgpr_write_b32 a7, 0
    v_accvgpr_write_b32 a8, 0
    v_accvgpr_write_b32 a9, 0
    v_accvgpr_write_b32 a10, 0
    v_accvgpr_write_b32 a11, 0
    v_accvgpr_write_b32 a12, 0
    v_accvgpr_write_b32 a13, 0
    v_accvgpr_write_b32 a14, 0
    v_accvgpr_write_b32 a15, 0
L_kg1:
    ds_read_b32 v61, v0 offset:16
    s_waitcnt lgkmcnt(0)
    v_readfirstlane_b32 s79, v61
    s_nop 0
    s_cmp_lt_u32 s79, 2
    s_cbranch_scc1 L_kg2
    s_cmp_eq_u32 s76, 0
    s_cbranch_scc1 L_kg2
    s_mov_b32 s78, 0
    s_branch Lspinf_37
Lspin_35:
    s_sleep 4
Lspinf_37:
    ds_read_b32 v61, v0 offset:20
    s_add_u32 s78, s78, 1
    s_waitcnt lgkmcnt(0)
    v_readfirstlane_b32 s79, v61
    s_cmp_gt_u32 s78, 0x200000
    s_cbranch_scc1 Lspind_36
    s_cmp_lt_u32 s79, 1
    s_cbranch_scc1 Lspin_35
Lspind_36:
L_kg2:
    s_add_u32 s76, s76, 1
    s_cmp_lt_u32 s76, 3
    s_cbranch_scc1 L_kg
    s_setprio 0
    s_mov_b32 s78, 0
    s_branch Lspinf_40
Lspin_38:
    s_sleep 1
Lspinf_40:
    ds_read_b32 v68, v0 offset:16
    s_add_u32 s78, s78, 1
    s_waitcnt lgkmcnt(0)
    v_readfirstlane_b32 s79, v68
    s_cmp_gt_u32 s78, 0x200000
    s_cbranch_scc1 Lspind_39
    s_cmp_lt_u32 s79, 1
    s_cbranch_scc1 Lspin_38
Lspind_39:
    v_add_u32 v29, 159744, v2
    v_mfma_f32_32x32x16_bf16 a[0:15], a[16:19], a[48:51], a[0:15]
    v_accvgpr_read_b32 v64, a80
    v_mfma_f32_32x32x16_bf16 a[0:15], a[20:23], a[52:55], a[0:15]
    v_accvgpr_read_b32 v65, a81
    v_accvgpr_read_b32 v66, a82
    v_accvgpr_read_b32 v67, a83
    v_accvgpr_read_b32 v100, a84
    v_mfma_f32_32x32x16_bf16 a[0:15], a[24:27], a[56:59], a[0:15]
    v_accvgpr_read_b32 v101, a85
    v_accvgpr_read_b32 v102, a86
    v_accvgpr_read_b32 v103, a87
    v_mfma_f32_32x32x16_bf16 a[0:15], a[28:31], a[60:63], a[0:15]
    v_accvgpr_read_b32 v104, a88
    v_accvgpr_read_b32 v105, a89
    v_accvgpr_read_b32 v106, a90
    v_accvgpr_read_b32 v107, a91
    v_mfma_f32_32x32x16_bf16 a[0:15], a[32:35], a[64:67], a[0:15]
    v_accvgpr_read_b32 v108, a92
    v_accvgpr_read_b32 v46, a93
    v_accvgpr_read_b32 v47, a94
    v_mfma_f32_32x32x16_bf16 a[0:15], a[36:39], a[68:71], a[0:15]
    v_accvgpr_read_b32 v48, a95
    v_accvgpr_read_b32 v49, a96
    v_accvgpr_read_b32 v16, a97
    v_mfma_f32_32x32x16_bf16 a[0:15], a[40:43], a[72:75], a[0:15]
    v_accvgpr_read_b32 v12, a98
    v_accvgpr_read_b32 v17, a99
    ds_read_b128 a[112:115], v29 offset:0
    ds_read_b128 a[116:119], v29 offset:1024
    v_mfma_f32_32x32x16_bf16 a[0:15], a[44:47], a[76:79], a[0:15]
    ds_read_b128 a[120:123], v29 offset:2048
    ds_read_b128 a[124:127], v29 offset:3072
    v_mov_b32 v76, 0
    v_mov_b32 v77, 0
    v_mov_b32 v78, 0
    v_mov_b32 v79, 0
    v_add_u32 v15, s77, v2
    ds_write_b128 v15, v[76:79] offset:1408
    ds_write_b128 v15, v[76:79] offset:2432
    ds_write_b128 v15, v[76:79] offset:3456
    ds_write_b128 v15, v[76:79] offset:4480
    s_mov_b64 exec, 3
    ds_write_b128 v15, v[76:79] offset:0
    s_mov_b32 exec_lo, -1
    ds_write_b128 v15, v[76:79] offset:10368
    s_mov_b64 exec, -1
    v_accvgpr_read_b32 v82, a0
    v_accvgpr_read_b32 v83, a1
    v_accvgpr_read_b32 v84, a2
    v_accvgpr_read_b32 v85, a3
    v_accvgpr_read_b32 v86, a4
    v_accvgpr_read_b32 v87, a5
    v_accvgpr_read_b32 v88, a6
    v_accvgpr_read_b32 v89, a7
    v_accvgpr_read_b32 v90, a8
    v_accvgpr_read_b32 v91, a9
    v_accvgpr_read_b32 v92, a10
    v_accvgpr_read_b32 v93, a11
    v_add_f32 v82, v82, v57
    v_cvt_pk_bf16_f32 v70, v82, v83
    v_cvt_pk_bf16_f32 v71, v84, v85
    v_cvt_pk_bf16_f32 v72, v86, v87
    v_cvt_pk_bf16_f32 v73, v88, v89
    v_cvt_pk_bf16_f32 v74, v90, v91
    v_cvt_pk_bf16_f32 v75, v92, v93
    ds_write_b64 v64, v[70:71]
    ds_write_b32 v65, v72
    ds_write_b32 v66, v73
    ds_write_b16 v67, v74 offset:1024
    s_mov_b32 exec_hi, 0
    ds_write_b16_d16_hi v67, v74 offset:1088
    ds_write_b16 v67, v75 offset:1152
    ds_write_b16_d16_hi v67, v75 offset:1216
    s_mov_b64 exec, -1
    s_mov_b32 exec_hi, 3
    ds_read_u16 v20, v100 offset:16
    ds_read_u16 v21, v100 offset:14
    ds_read_u16 v22, v100 offset:12
    ds_read_u16 v23, v100 offset:10
    ds_read_u16 v24, v100 offset:8
    ds_read_u16 v25, v100 offset:6
    ds_read_u16 v26, v100 offset:4
    ds_read_u16 v27, v100 offset:2
    ds_read_u16 v28, v100 offset:0
    s_mov_b32 exec_hi, 0
    ds_read_u16 v29, v102 offset:8
    ds_read_u16 v30, v102 offset:6
    ds_read_u16 v31, v102 offset:4
    ds_read_u16 v32, v102 offset:2
    ds_read_u16 v33, v102 offset:0
    ds_read_u16 v40, v105
    s_mov_b64 exec, -1
    ds_read_u16 v41, v106 offset:808
    ds_read_u16 v43, v106 offset:1060
    ds_read_u16 v42, v106 offset:936
    ds_read_u16 v44, v106 offset:1188
    s_waitcnt lgkmcnt(10)
    v_lshl_or_b32 v70, v22, 16, v21
    v_lshl_or_b32 v71, v24, 16, v23
    v_lshl_or_b32 v72, v26, 16, v25
    v_lshl_or_b32 v73, v28, 16, v27
    v_lshl_or_b32 v74, v21, 16, v20
    v_lshl_or_b32 v75, v23, 16, v22
    v_lshl_or_b32 v76, v25, 16, v24
    v_lshl_or_b32 v77, v27, 16, v26
    s_mov_b32 exec_hi, 3
    ds_write_b128 v101, v[70:73] offset:1408
    ds_write_b128 v101, v[74:77] offset:2752
    s_mov_b64 exec, -1
    s_waitcnt lgkmcnt(7)
    v_lshl_or_b32 v78, v30, 16, v29
    v_lshl_or_b32 v79, v31, 16, v31
    v_lshl_or_b32 v80, v32, 16, v31
    v_lshl_or_b32 v81, v33, 16, v33
    v_lshl_or_b32 v82, v29, 16, v29
    v_lshl_or_b32 v83, v31, 16, v30
    v_lshl_or_b32 v84, v31, 16, v31
    v_lshl_or_b32 v85, v33, 16, v32
    s_mov_b32 exec_hi, 0
    ds_write_b128 v103, v[78:81] offset:1408
    ds_write_b128 v103, v[82:85] offset:2752
    s_mov_b64 exec, -1
    s_waitcnt lgkmcnt(4)
    ds_write_b16 v107, v41 offset:188
    ds_write_b16 v108, v43 offset:702
    ds_write_b16 v108, v43 offset:1088
    s_mov_b32 exec_hi, 0x7fffffff
    ds_write_b16 v108, v44 offset:638
    ds_write_b16 v108, v44 offset:1024
    s_mov_b32 exec_hi, 0x1fffffff
    ds_write_b16 v107, v42 offset:124
    s_mov_b32 exec_hi, 0
    s_mov_b32 exec_lo, 0x01ff3fff
    ds_write_b16 v104, v40 offset:1408
    ds_write_b16 v104, v40 offset:2754
    s_mov_b64 exec, -1
    ds_read2_b32 a[0:1], v47 offset0:160 offset1:161
    ds_read2_b32 a[2:3], v47 offset0:162 offset1:163
    ds_read2_b32 a[4:5], v47 offset0:144 offset1:145
    ds_read2_b32 a[6:7], v47 offset0:146 offset1:147
    ds_read2_b32 a[8:9], v47 offset0:128 offset1:129
    ds_read2_b32 a[10:11], v47 offset0:130 offset1:131
    ds_read2_b32 a[12:13], v47 offset0:112 offset1:113
    ds_read2_b32 a[14:15], v47 offset0:114 offset1:115
    ds_read2_b32 a[16:17], v47 offset0:96 offset1:97
    ds_read2_b32 a[18:19], v47 offset0:98 offset1:99
    ds_read2_b32 a[20:21], v47 offset0:80 offset1:81
    ds_read2_b32 a[22:23], v47 offset0:82 offset1:83
    ds_read2_b32 a[24:25], v47 offset0:64 offset1:65
    ds_read2_b32 a[26:27], v47 offset0:66 offset1:67
    ds_read2_b32 a[28:29], v47 offset0:48 offset1:49
    ds_read2_b32 a[30:31], v47 offset0:50 offset1:51
    ds_read2_b32 a[32:33], v47 offset0:32 offset1:33
    ds_read2_b32 a[34:35], v47 offset0:34 offset1:35
    ds_read2_b32 a[36:37], v47 offset0:16 offset1:17
    ds_read2_b32 a[38:39], v47 offset0:18 offset1:19
    ds_read2_b32 a[40:41], v47 offset0:0 offset1:1
    ds_read2_b32 a[42:43], v47 offset0:2 offset1:3
    ds_read2_b32 a[44:45], v46 offset0:112 offset1:113
    ds_read2_b32 a[46:47], v46 offset0:114 offset1:115
    ds_read2_b32 a[48:49], v46 offset0:96 offset1:97
    ds_read2_b32 a[50:51], v46 offset0:98 offset1:99
    ds_read2_b32 a[52:53], v46 offset0:80 offset1:81
    ds_read2_b32 a[54:55], v46 offset0:82 offset1:83
    ds_read2_b32 a[56:57], v46 offset0:64 offset1:65
    ds_read2_b32 a[58:59], v46 offset0:66 offset1:67
    ds_read2_b32 a[60:61], v46 offset0:48 offset1:49
    ds_read2_b32 a[62:63], v46 offset0:50 offset1:51
    ds_read2_b32 a[64:65], v46 offset0:32 offset1:33
    ds_read2_b32 a[66:67], v46 offset0:34 offset1:35
    ds_read2_b32 a[68:69], v46 offset0:0 offset1:1
    ds_read2_b32 a[70:71], v46 offset0:2 offset1:3
    ds_read2_b32 a[72:73], v48 offset0:0 offset1:1
    ds_read2_b32 a[74:75], v48 offset0:68 offset1:69
    ds_read2_b32 a[76:77], v48 offset0:8 offset1:9
    ds_read2_b32 a[78:79], v48 offset0:76 offset1:77
    ds_read2_b32 a[80:81], v48 offset0:16 offset1:17
    ds_read2_b32 a[82:83], v48 offset0:84 offset1:85
    ds_read2_b32 a[84:85], v48 offset0:24 offset1:25
    ds_read2_b32 a[86:87], v48 offset0:92 offset1:93
    ds_read2_b32 a[88:89], v48 offset0:32 offset1:33
    ds_read2_b32 a[90:91], v48 offset0:100 offset1:101
    ds_read2_b32 a[92:93], v48 offset0:40 offset1:41
    ds_read2_b32 a[94:95], v48 offset0:108 offset1:109
    ds_read2_b32 a[96:97], v49 offset0:0 offset1:1
    ds_read2_b32 a[98:99], v49 offset0:48 offset1:49
    ds_read2_b32 a[100:101], v49 offset0:8 offset1:9
    ds_read2_b32 a[102:103], v49 offset0:56 offset1:57
    ds_read2_b32 a[104:105], v49 offset0:16 offset1:17
    ds_read2_b32 a[106:107], v49 offset0:64 offset1:65
    ds_read2_b32 a[108:109], v49 offset0:24 offset1:25
    ds_read2_b32 a[110:111], v49 offset0:72 offset1:73
    s_setprio 0
    s_mov_b32 s78, 0
    s_branch Lspinf_43
Lspin_41:
    s_sleep 2
Lspinf_43:
    ds_read_b32 v22, v0 offset:68
    s_add_u32 s78, s78, 1
    s_waitcnt lgkmcnt(0)
    v_readfirstlane_b32 s79, v22
    s_cmp_gt_u32 s78, 0x200000
    s_cbranch_scc1 Lspind_42
    s_cmp_lt_u32 s79, 1
    s_cbranch_scc1 Lspin_41
Lspind_42:
    ds_read_b32 v9, v0 offset:44
    ds_read_b128 v[24:27], v16 offset:432
    ds_read_b128 v[28:31], v16 offset:448
    ds_read_b128 v[32:35], v16 offset:448
    ds_read_b128 v[36:39], v16 offset:960
    ds_read_b128 v[40:43], v16 offset:1472
    ds_read_b128 v[44:47], v16 offset:1984
    ds_read_b128 v[48:51], v16 offset:944
    ds_read_b128 v[52:55], v16 offset:960
    ds_read_b128 v[56:59], v16 offset:2496
    ds_read_b128 v[60:63], v16 offset:3008
    ds_read_b128 v[96:99], v16 offset:3520
    ds_read_b128 v[100:103], v16 offset:4032
    ds_read_b128 v[104:107], v16 offset:1456
    ds_read_b128 v[108:111], v16 offset:1472
    ds_read_b128 v[112:115], v16 offset:384
    s_mov_b32 s78, 0
    s_branch Lspinf_46
Lspin_44:
    s_sleep 1
Lspinf_46:
    ds_read_b32 v22, v0 offset:12
    s_add_u32 s78, s78, 1
    s_waitcnt lgkmcnt(0)
    v_readfirstlane_b32 s79, v22
    s_cmp_gt_u32 s78, 0x200000
    s_cbranch_scc1 Lspind_45
    s_cmp_lt_u32 s79, 4
    s_cbranch_scc1 Lspin_44
Lspind_45:
    s_setprio 0
    v_mfma_f32_16x16x32_bf16 v[116:119], v[24:27], a[120:123], 0
    v_mfma_f32_16x16x32_bf16 v[120:123], v[28:31], a[124:127], 0
    v_mfma_f32_16x16x32_bf16 v[64:67], a[0:3], v[32:35], 0
    ds_read_b128 v[24:27], v16 offset:896
    ds_read_b128 v[28:31], v16 offset:1408
    v_mfma_f32_16x16x32_bf16 v[68:71], a[32:35], v[32:35], 0
    v_mfma_f32_16x16x32_bf16 v[72:75], a[64:67], v[32:35], 0
    v_mfma_f32_16x16x32_bf16 v[80:83], a[68:71], v[32:35], 0
    v_mfma_f32_16x16x32_bf16 v[68:71], a[0:3], v[36:39], v[68:71]
    ds_read_b128 v[32:35], v16 offset:1920
    v_mfma_f32_16x16x32_bf16 v[72:75], a[32:35], v[36:39], v[72:75]
    v_mfma_f32_16x16x32_bf16 v[76:79], a[64:67], v[36:39], 0
    v_mfma_f32_16x16x32_bf16 v[84:87], a[68:71], v[36:39], 0
    v_mfma_f32_16x16x32_bf16 v[72:75], a[0:3], v[40:43], v[72:75]
    ds_read_b128 v[36:39], v16 offset:1968
    v_mfma_f32_16x16x32_bf16 v[76:79], a[32:35], v[40:43], v[76:79]
    v_mfma_f32_16x16x32_bf16 v[80:83], a[64:67], v[40:43], v[80:83]
    v_mfma_f32_16x16x32_bf16 v[88:91], a[68:71], v[40:43], 0
    v_cvt_pk_bf16_f32 v124, v116, v117
    v_cvt_pk_bf16_f32 v125, v118, v119
    v_cvt_pk_bf16_f32 v126, v120, v121
    v_cvt_pk_bf16_f32 v127, v122, v123
    v_mfma_f32_16x16x32_bf16 v[76:79], a[0:3], v[44:47], v[76:79]
    ds_read_b128 v[40:43], v16 offset:1984
    v_mfma_f32_16x16x32_bf16 v[80:83], a[32:35], v[44:47], v[80:83]
    v_mfma_f32_16x16x32_bf16 v[84:87], a[64:67], v[44:47], v[84:87]
    v_mfma_f32_16x16x32_bf16 v[92:95], a[68:71], v[44:47], 0
    v_mfma_f32_16x16x32_bf16 v[80:83], v[124:127], a[108:111], v[80:83]
    v_mfma_f32_16x16x32_bf16 v[84:87], v[124:127], a[104:107], v[84:87]
    v_mfma_f32_16x16x32_bf16 v[88:91], v[124:127], a[100:103], v[88:91]
    v_mfma_f32_16x16x32_bf16 v[92:95], v[124:127], a[96:99], v[92:95]
    v_mfma_f32_16x16x32_bf16 v[116:119], v[48:51], a[120:123], 0
    ds_read_b128 v[44:47], v16 offset:2432
    v_mfma_f32_16x16x32_bf16 v[120:123], v[52:55], a[124:127], 0
    v_mfma_f32_16x16x32_bf16 v[80:83], a[0:3], v[56:59], v[80:83]
    ds_read_b128 v[48:51], v16 offset:2944
    ds_read_b128 v[52:55], v16 offset:3456
    v_mfma_f32_16x16x32_bf16 v[84:87], a[32:35], v[56:59], v[84:87]
    v_mfma_f32_16x16x32_bf16 v[88:91], a[64:67], v[56:59], v[88:91]
    v_mfma_f32_16x16x32_bf16 v[84:87], a[0:3], v[60:63], v[84:87]
    ds_read_b128 v[56:59], v16 offset:3968
    v_mfma_f32_16x16x32_bf16 v[88:91], a[32:35], v[60:63], v[88:91]
    v_mfma_f32_16x16x32_bf16 v[92:95], a[64:67], v[60:63], v[92:95]
    v_mfma_f32_16x16x32_bf16 v[88:91], a[0:3], v[96:99], v[88:91]
    ds_read_b128 v[60:63], v12 offset:0
    v_mfma_f32_16x16x32_bf16 v[92:95], a[32:35], v[96:99], v[92:95]
    v_cvt_pk_bf16_f32 v124, v116, v117
    v_cvt_pk_bf16_f32 v125, v118, v119
    v_cvt_pk_bf16_f32 v126, v120, v121
    v_cvt_pk_bf16_f32 v127, v122, v123
    v_mfma_f32_16x16x32_bf16 v[92:95], a[0:3], v[100:103], v[92:95]
    ds_read_b128 v[96:99], v16 offset:320
    v_mfma_f32_16x16x32_bf16 v[84:87], v[124:127], a[108:111], v[84:87]
    v_mfma_f32_16x16x32_bf16 v[88:91], v[124:127], a[104:107], v[88:91]
    v_mfma_f32_16x16x32_bf16 v[92:95], v[124:127], a[100:103], v[92:95]
    v_mfma_f32_16x16x32_bf16 v[116:119], v[104:107], a[120:123], 0
    ds_read_b128 v[100:103], v16 offset:832
    v_mfma_f32_16x16x32_bf16 v[120:123], v[108:111], a[124:127], 0
    v_mfma_f32_16x16x32_bf16 v[64:67], a[4:7], v[112:115], v[64:67]
    ds_read_b128 v[104:107], v16 offset:1344
    ds_read_b128 v[108:111], v16 offset:1856
    v_mfma_f32_16x16x32_bf16 v[68:71], a[36:39], v[112:115], v[68:71]
    s_waitcnt lgkmcnt(13)
    v_mfma_f32_16x16x32_bf16 v[68:71], a[4:7], v[24:27], v[68:71]
    ds_read_b128 v[112:115], v12 offset:256
    v_mfma_f32_16x16x32_bf16 v[72:75], a[36:39], v[24:27], v[72:75]
    s_waitcnt lgkmcnt(13)
    v_mfma_f32_16x16x32_bf16 v[72:75], a[4:7], v[28:31], v[72:75]
    ds_read_b128 v[24:27], v16 offset:2368
    v_mfma_f32_16x16x32_bf16 v[76:79], a[36:39], v[28:31], v[76:79]
    v_cvt_pk_bf16_f32 v124, v116, v117
    v_cvt_pk_bf16_f32 v125, v118, v119
    v_cvt_pk_bf16_f32 v126, v120, v121
    v_cvt_pk_bf16_f32 v127, v122, v123
    s_waitcnt lgkmcnt(13)
    v_mfma_f32_16x16x32_bf16 v[76:79], a[4:7], v[32:35], v[76:79]
    ds_read_b128 v[28:31], v16 offset:2880
    v_mfma_f32_16x16x32_bf16 v[80:83], a[36:39], v[32:35], v[80:83]
    v_mfma_f32_16x16x32_bf16 v[88:91], v[124:127], a[108:111], v[88:91]
    v_mfma_f32_16x16x32_bf16 v[92:95], v[124:127], a[104:107], v[92:95]
    s_waitcnt lgkmcnt(12)
    v_mfma_f32_16x16x32_bf16 v[116:119], v[36:39], a[120:123], 0
    ds_read_b128 v[32:35], v16 offset:3392
    v_mfma_f32_16x16x32_bf16 v[120:123], v[40:43], a[124:127], 0
    s_waitcnt lgkmcnt(12)
    v_mfma_f32_16x16x32_bf16 v[80:83], a[4:7], v[44:47], v[80:83]
    ds_read_b128 v[36:39], v16 offset:3904
    ds_read_b128 v[40:43], v12 offset:512
    v_mfma_f32_16x16x32_bf16 v[84:87], a[36:39], v[44:47], v[84:87]
    s_waitcnt lgkmcnt(13)
    v_mfma_f32_16x16x32_bf16 v[84:87], a[4:7], v[48:51], v[84:87]
    ds_read_b128 v[44:47], v16 offset:256
    v_mfma_f32_16x16x32_bf16 v[88:91], a[36:39], v[48:51], v[88:91]
    s_waitcnt lgkmcnt(13)
    v_mfma_f32_16x16x32_bf16 v[88:91], a[4:7], v[52:55], v[88:91]
    ds_read_b128 v[48:51], v16 offset:768
    v_mfma_f32_16x16x32_bf16 v[92:95], a[36:39], v[52:55], v[92:95]
    v_cvt_pk_bf16_f32 v124, v116, v117
    v_cvt_pk_bf16_f32 v125, v118, v119
    v_cvt_pk_bf16_f32 v126, v120, v121
    v_cvt_pk_bf16_f32 v127, v122, v123
    s_waitcnt lgkmcnt(13)
    v_mfma_f32_16x16x32_bf16 v[92:95], a[4:7], v[56:59], v[92:95]
    ds_read_b128 v[52:55], v16 offset:1280
    v_mfma_f32_16x16x32_bf16 v[92:95], v[124:127], a[108:111], v[92:95]
    s_waitcnt lgkmcnt(13)
    v_mfma_f32_16x16x32_bf16 v[116:119], v[60:63], a[112:115], 0
    ds_read_b128 v[56:59], v16 offset:1792
    v_mfma_f32_16x16x32_bf16 v[120:123], v[60:63], a[116:119], 0
    s_waitcnt lgkmcnt(13)
    v_mfma_f32_16x16x32_bf16 v[64:67], a[8:11], v[96:99], v[64:67]
    ds_read_b128 v[60:63], v12 offset:768
    v_mfma_f32_16x16x32_bf16 v[68:71], a[40:43], v[96:99], v[68:71]
    s_waitcnt lgkmcnt(13)
    v_mfma_f32_16x16x32_bf16 v[68:71], a[8:11], v[100:103], v[68:71]
    ds_read_b128 v[96:99], v16 offset:2304
    v_mfma_f32_16x16x32_bf16 v[72:75], a[40:43], v[100:103], v[72:75]
    s_waitcnt lgkmcnt(13)
    v_mfma_f32_16x16x32_bf16 v[72:75], a[8:11], v[104:107], v[72:75]
    ds_read_b128 v[100:103], v16 offset:2816
    v_mfma_f32_16x16x32_bf16 v[76:79], a[40:43], v[104:107], v[76:79]
    v_cvt_pk_bf16_f32 v124, v116, v117
    v_cvt_pk_bf16_f32 v125, v118, v119
    v_cvt_pk_bf16_f32 v126, v120, v121
    v_cvt_pk_bf16_f32 v127, v122, v123
    s_waitcnt lgkmcnt(13)
    v_mfma_f32_16x16x32_bf16 v[76:79], a[8:11], v[108:111], v[76:79]
    ds_read_b128 v[104:107], v16 offset:3328
    v_mfma_f32_16x16x32_bf16 v[80:83], a[40:43], v[108:111], v[80:83]
    v_mfma_f32_16x16x32_bf16 v[72:75], v[124:127], a[88:91], v[72:75]
    v_mfma_f32_16x16x32_bf16 v[76:79], v[124:127], a[80:83], v[76:79]
    v_mfma_f32_16x16x32_bf16 v[80:83], v[124:127], a[72:75], v[80:83]
    s_waitcnt lgkmcnt(13)
    v_mfma_f32_16x16x32_bf16 v[116:119], v[112:115], a[112:115], 0
    ds_read_b128 v[108:111], v16 offset:3840
    v_mfma_f32_16x16x32_bf16 v[120:123], v[112:115], a[116:119], 0
    s_waitcnt lgkmcnt(13)
    v_mfma_f32_16x16x32_bf16 v[80:83], a[8:11], v[24:27], v[80:83]
    ds_read_b128 v[112:115], v12 offset:1024
    v_mfma_f32_16x16x32_bf16 v[84:87], a[40:43], v[24:27], v[84:87]
    s_waitcnt lgkmcnt(13)
    v_mfma_f32_16x16x32_bf16 v[84:87], a[8:11], v[28:31], v[84:87]
    ds_read_b128 v[24:27], v16 offset:192
    v_mfma_f32_16x16x32_bf16 v[88:91], a[40:43], v[28:31], v[88:91]
    s_waitcnt lgkmcnt(13)
    v_mfma_f32_16x16x32_bf16 v[88:91], a[8:11], v[32:35], v[88:91]
    ds_read_b128 v[28:31], v16 offset:704
    v_mfma_f32_16x16x32_bf16 v[92:95], a[40:43], v[32:35], v[92:95]
    v_cvt_pk_bf16_f32 v124, v116, v117
    v_cvt_pk_bf16_f32 v125, v118, v119
    v_cvt_pk_bf16_f32 v126, v120, v121
    v_cvt_pk_bf16_f32 v127, v122, v123
    s_setprio 3
    s_waitcnt lgkmcnt(13)
    v_mfma_f32_16x16x32_bf16 v[92:95], a[8:11], v[36:39], v[92:95]
    ds_read_b128 v[32:35], v16 offset:1216
    v_mfma_f32_16x16x32_bf16 v[72:75], v[124:127], a[92:95], v[72:75]
    v_mfma_f32_16x16x32_bf16 v[76:79], v[124:127], a[84:87], v[76:79]
    v_mfma_f32_16x16x32_bf16 v[80:83], v[124:127], a[76:79], v[80:83]
    s_waitcnt lgkmcnt(13)
    v_mfma_f32_16x16x32_bf16 v[116:119], v[40:43], a[112:115], 0
    ds_read_b128 v[36:39], v16 offset:1728
    v_mfma_f32_16x16x32_bf16 v[120:123], v[40:43], a[116:119], 0
    s_waitcnt lgkmcnt(13)
    v_mfma_f32_16x16x32_bf16 v[64:67], a[12:15], v[44:47], v[64:67]
    ds_read_b128 v[40:43], v12 offset:1280
    v_mfma_f32_16x16x32_bf16 v[68:71], a[44:47], v[44:47], v[68:71]
    s_waitcnt lgkmcnt(13)
    v_mfma_f32_16x16x32_bf16 v[68:71], a[12:15], v[48:51], v[68:71]
    ds_read_b128 v[44:47], v16 offset:2240
    v_mfma_f32_16x16x32_bf16 v[72:75], a[44:47], v[48:51], v[72:75]
    s_waitcnt lgkmcnt(13)
    v_mfma_f32_16x16x32_bf16 v[72:75], a[12:15], v[52:55], v[72:75]
    ds_read_b128 v[48:51], v16 offset:2752
    v_mfma_f32_16x16x32_bf16 v[76:79], a[44:47], v[52:55], v[76:79]
    v_cvt_pk_bf16_f32 v124, v116, v117
    v_cvt_pk_bf16_f32 v125, v118, v119
    v_cvt_pk_bf16_f32 v126, v120, v121
    v_cvt_pk_bf16_f32 v127, v122, v123
    s_waitcnt lgkmcnt(13)
    v_mfma_f32_16x16x32_bf16 v[76:79], a[12:15], v[56:59], v[76:79]
    ds_read_b128 v[52:55], v16 offset:3264
    v_mfma_f32_16x16x32_bf16 v[80:83], a[44:47], v[56:59], v[80:83]
    v_mfma_f32_16x16x32_bf16 v[76:79], v[124:127], a[88:91], v[76:79]
    v_mfma_f32_16x16x32_bf16 v[80:83], v[124:127], a[80:83], v[80:83]
    v_mfma_f32_16x16x32_bf16 v[84:87], v[124:127], a[72:75], v[84:87]
    s_waitcnt lgkmcnt(13)
    v_mfma_f32_16x16x32_bf16 v[116:119], v[60:63], a[112:115], 0
    ds_read_b128 v[56:59], v16 offset:3776
    v_mfma_f32_16x16x32_bf16 v[120:123], v[60:63], a[116:119], 0
    s_waitcnt lgkmcnt(13)
    v_mfma_f32_16x16x32_bf16 v[80:83], a[12:15], v[96:99], v[80:83]
    ds_read_b128 v[60:63], v12 offset:1536
    v_mfma_f32_16x16x32_bf16 v[84:87], a[44:47], v[96:99], v[84:87]
    s_waitcnt lgkmcnt(13)
    v_mfma_f32_16x16x32_bf16 v[84:87], a[12:15], v[100:103], v[84:87]
    ds_read_b128 v[96:99], v16 offset:128
    v_mfma_f32_16x16x32_bf16 v[88:91], a[44:47], v[100:103], v[88:91]
    s_waitcnt lgkmcnt(13)
    v_mfma_f32_16x16x32_bf16 v[88:91], a[12:15], v[104:107], v[88:91]
    ds_read_b128 v[100:103], v16 offset:640
    v_mfma_f32_16x16x32_bf16 v[92:95], a[44:47], v[104:107], v[92:95]
    v_cvt_pk_bf16_f32 v124, v116, v117
    v_cvt_pk_bf16_f32 v125, v118, v119
    v_cvt_pk_bf16_f32 v126, v120, v121
    v_cvt_pk_bf16_f32 v127, v122, v123
    s_waitcnt lgkmcnt(13)
    v_mfma_f32_16x16x32_bf16 v[92:95], a[12:15], v[108:111], v[92:95]
    ds_read_b128 v[104:107], v16 offset:1152
    v_mfma_f32_16x16x32_bf16 v[76:79], v[124:127], a[92:95], v[76:79]
    v_mfma_f32_16x16x32_bf16 v[80:83], v[124:127], a[84:87], v[80:83]
    v_mfma_f32_16x16x32_bf16 v[84:87], v[124:127], a[76:79], v[84:87]
    s_waitcnt lgkmcnt(13)
    v_mfma_f32_16x16x32_bf16 v[116:119], v[112:115], a[112:115], 0
    ds_read_b128 v[108:111], v16 offset:1664
    v_mfma_f32_16x16x32_bf16 v[120:123], v[112:115], a[116:119], 0
    s_waitcnt lgkmcnt(13)
    v_mfma_f32_16x16x32_bf16 v[64:67], a[16:19], v[24:27], v[64:67]
    ds_read_b128 v[112:115], v12 offset:1792
    v_mfma_f32_16x16x32_bf16 v[68:71], a[48:51], v[24:27], v[68:71]
    s_waitcnt lgkmcnt(13)
    v_mfma_f32_16x16x32_bf16 v[68:71], a[16:19], v[28:31], v[68:71]
    ds_read_b128 v[24:27], v16 offset:2176
    v_mfma_f32_16x16x32_bf16 v[72:75], a[48:51], v[28:31], v[72:75]
    s_waitcnt lgkmcnt(13)
    v_mfma_f32_16x16x32_bf16 v[72:75], a[16:19], v[32:35], v[72:75]
    ds_read_b128 v[28:31], v16 offset:2688
    v_mfma_f32_16x16x32_bf16 v[76:79], a[48:51], v[32:35], v[76:79]
    v_cvt_pk_bf16_f32 v124, v116, v117
    v_cvt_pk_bf16_f32 v125, v118, v119
    v_cvt_pk_bf16_f32 v126, v120, v121
    v_cvt_pk_bf16_f32 v127, v122, v123
    s_waitcnt lgkmcnt(13)
    v_mfma_f32_16x16x32_bf16 v[76:79], a[16:19], v[36:39], v[76:79]
    ds_read_b128 v[32:35], v16 offset:3200
    v_mfma_f32_16x16x32_bf16 v[80:83], a[48:51], v[36:39], v[80:83]
    v_mfma_f32_16x16x32_bf16 v[80:83], v[124:127], a[88:91], v[80:83]
    v_mfma_f32_16x16x32_bf16 v[84:87], v[124:127], a[80:83], v[84:87]
    v_mfma_f32_16x16x32_bf16 v[88:91], v[124:127], a[72:75], v[88:91]
    s_waitcnt lgkmcnt(13)
    v_mfma_f32_16x16x32_bf16 v[116:119], v[40:43], a[112:115], 0
    ds_read_b128 v[36:39], v16 offset:3712
    v_mfma_f32_16x16x32_bf16 v[120:123], v[40:43], a[116:119], 0
    s_waitcnt lgkmcnt(13)
    v_mfma_f32_16x16x32_bf16 v[80:83], a[16:19], v[44:47], v[80:83]
    ds_read_b128 v[40:43], v12 offset:2048
    v_mfma_f32_16x16x32_bf16 v[84:87], a[48:51], v[44:47], v[84:87]
    s_waitcnt lgkmcnt(13)
    v_mfma_f32_16x16x32_bf16 v[84:87], a[16:19], v[48:51], v[84:87]
    ds_read_b128 v[44:47], v16 offset:64
    v_mfma_f32_16x16x32_bf16 v[88:91], a[48:51], v[48:51], v[88:91]
    s_waitcnt lgkmcnt(13)
    v_mfma_f32_16x16x32_bf16 v[88:91], a[16:19], v[52:55], v[88:91]
    ds_read_b128 v[48:51], v16 offset:576
    v_mfma_f32_16x16x32_bf16 v[92:95], a[48:51], v[52:55], v[92:95]
    v_cvt_pk_bf16_f32 v124, v116, v117
    v_cvt_pk_bf16_f32 v125, v118, v119
    v_cvt_pk_bf16_f32 v126, v120, v121
    v_cvt_pk_bf16_f32 v127, v122, v123
    s_waitcnt lgkmcnt(13)
    v_mfma_f32_16x16x32_bf16 v[92:95], a[16:19], v[56:59], v[92:95]
    ds_read_b128 v[52:55], v16 offset:1088
    v_mfma_f32_16x16x32_bf16 v[80:83], v[124:127], a[92:95], v[80:83]
    v_mfma_f32_16x16x32_bf16 v[84:87], v[124:127], a[84:87], v[84:87]
    v_mfma_f32_16x16x32_bf16 v[88:91], v[124:127], a[76:79], v[88:91]
    s_waitcnt lgkmcnt(13)
    v_mfma_f32_16x16x32_bf16 v[116:119], v[60:63], a[112:115], 0
    ds_read_b128 v[56:59], v16 offset:1600
    v_mfma_f32_16x16x32_bf16 v[120:123], v[60:63], a[116:119], 0
    s_waitcnt lgkmcnt(13)
    v_mfma_f32_16x16x32_bf16 v[64:67], a[20:23], v[96:99], v[64:67]
    ds_read_b128 v[60:63], v12 offset:2304
    v_mfma_f32_16x16x32_bf16 v[68:71], a[52:55], v[96:99], v[68:71]
    s_waitcnt lgkmcnt(13)
    v_mfma_f32_16x16x32_bf16 v[68:71], a[20:23], v[100:103], v[68:71]
    ds_read_b128 v[96:99], v16 offset:2112
    v_mfma_f32_16x16x32_bf16 v[72:75], a[52:55], v[100:103], v[72:75]
    s_waitcnt lgkmcnt(13)
    v_mfma_f32_16x16x32_bf16 v[72:75], a[20:23], v[104:107], v[72:75]
    ds_read_b128 v[100:103], v16 offset:2624
    v_mfma_f32_16x16x32_bf16 v[76:79], a[52:55], v[104:107], v[76:79]
    v_cvt_pk_bf16_f32 v124, v116, v117
    v_cvt_pk_bf16_f32 v125, v118, v119
    v_cvt_pk_bf16_f32 v126, v120, v121
    v_cvt_pk_bf16_f32 v127, v122, v123
    s_waitcnt lgkmcnt(13)
    v_mfma_f32_16x16x32_bf16 v[76:79], a[20:23], v[108:111], v[76:79]
    ds_read_b128 v[104:107], v16 offset:3136
    v_mfma_f32_16x16x32_bf16 v[80:83], a[52:55], v[108:111], v[80:83]
    v_mfma_f32_16x16x32_bf16 v[84:87], v[124:127], a[88:91], v[84:87]
    v_mfma_f32_16x16x32_bf16 v[88:91], v[124:127], a[80:83], v[88:91]
    v_mfma_f32_16x16x32_bf16 v[92:95], v[124:127], a[72:75], v[92:95]
    s_waitcnt lgkmcnt(13)
    v_mfma_f32_16x16x32_bf16 v[116:119], v[112:115], a[112:115], 0
    ds_read_b128 v[108:111], v16 offset:3648
    v_mfma_f32_16x16x32_bf16 v[120:123], v[112:115], a[116:119], 0
    s_waitcnt lgkmcnt(13)
    v_mfma_f32_16x16x32_bf16 v[80:83], a[20:23], v[24:27], v[80:83]
    ds_read_b128 v[112:115], v12 offset:2560
    v_mfma_f32_16x16x32_bf16 v[84:87], a[52:55], v[24:27], v[84:87]
    s_waitcnt lgkmcnt(13)
    v_mfma_f32_16x16x32_bf16 v[84:87], a[20:23], v[28:31], v[84:87]
    ds_read_b128 v[24:27], v16 offset:0
    v_mfma_f32_16x16x32_bf16 v[88:91], a[52:55], v[28:31], v[88:91]
    s_waitcnt lgkmcnt(13)
    v_mfma_f32_16x16x32_bf16 v[88:91], a[20:23], v[32:35], v[88:91]
    ds_read_b128 v[28:31], v16 offset:512
    v_mfma_f32_16x16x32_bf16 v[92:95], a[52:55], v[32:35], v[92:95]
    v_cvt_pk_bf16_f32 v124, v116, v117
    v_cvt_pk_bf16_f32 v125, v118, v119
    v_cvt_pk_bf16_f32 v126, v120, v121
    v_cvt_pk_bf16_f32 v127, v122, v123
    s_waitcnt lgkmcnt(13)
    v_mfma_f32_16x16x32_bf16 v[92:95], a[20:23], v[36:39], v[92:95]
    ds_read_b128 v[32:35], v16 offset:1024
    v_mfma_f32_16x16x32_bf16 v[84:87], v[124:127], a[92:95], v[84:87]
    v_mfma_f32_16x16x32_bf16 v[88:91], v[124:127], a[84:87], v[88:91]
    v_mfma_f32_16x16x32_bf16 v[92:95], v[124:127], a[76:79], v[92:95]
    s_waitcnt lgkmcnt(13)
    v_mfma_f32_16x16x32_bf16 v[116:119], v[40:43], a[112:115], 0
    ds_read_b128 v[36:39], v16 offset:1536
    v_mfma_f32_16x16x32_bf16 v[120:123], v[40:43], a[116:119], 0
    s_waitcnt lgkmcnt(13)
    v_mfma_f32_16x16x32_bf16 v[64:67], a[24:27], v[44:47], v[64:67]
    ds_read_b128 v[40:43], v12 offset:2816
    v_mfma_f32_16x16x32_bf16 v[68:71], a[56:59], v[44:47], v[68:71]
    s_waitcnt lgkmcnt(13)
    v_mfma_f32_16x16x32_bf16 v[68:71], a[24:27], v[48:51], v[68:71]
    ds_read_b128 v[44:47], v16 offset:2048
    v_mfma_f32_16x16x32_bf16 v[72:75], a[56:59], v[48:51], v[72:75]
    s_waitcnt lgkmcnt(13)
    v_mfma_f32_16x16x32_bf16 v[72:75], a[24:27], v[52:55], v[72:75]
    ds_read_b128 v[48:51], v16 offset:2560
    v_mfma_f32_16x16x32_bf16 v[76:79], a[56:59], v[52:55], v[76:79]
    v_cvt_pk_bf16_f32 v124, v116, v117
    v_cvt_pk_bf16_f32 v125, v118, v119
    v_cvt_pk_bf16_f32 v126, v120, v121
    v_cvt_pk_bf16_f32 v127, v122, v123
    s_waitcnt lgkmcnt(13)
    v_mfma_f32_16x16x32_bf16 v[76:79], a[24:27], v[56:59], v[76:79]
    ds_read_b128 v[52:55], v16 offset:3072
    v_mfma_f32_16x16x32_bf16 v[80:83], a[56:59], v[56:59], v[80:83]
    v_mfma_f32_16x16x32_bf16 v[88:91], v[124:127], a[88:91], v[88:91]
    v_mfma_f32_16x16x32_bf16 v[92:95], v[124:127], a[80:83], v[92:95]
    s_waitcnt lgkmcnt(13)
    v_mfma_f32_16x16x32_bf16 v[116:119], v[60:63], a[112:115], 0
    ds_read_b128 v[56:59], v16 offset:3584
    v_mfma_f32_16x16x32_bf16 v[120:123], v[60:63], a[116:119], 0
    s_waitcnt lgkmcnt(13)
    v_mfma_f32_16x16x32_bf16 v[80:83], a[24:27], v[96:99], v[80:83]
    v_mfma_f32_16x16x32_bf16 v[84:87], a[56:59], v[96:99], v[84:87]
    s_waitcnt lgkmcnt(12)
    v_mfma_f32_16x16x32_bf16 v[84:87], a[24:27], v[100:103], v[84:87]
    v_mfma_f32_16x16x32_bf16 v[88:91], a[56:59], v[100:103], v[88:91]
    s_waitcnt lgkmcnt(11)
    v_mfma_f32_16x16x32_bf16 v[88:91], a[24:27], v[104:107], v[88:91]
    v_mfma_f32_16x16x32_bf16 v[92:95], a[56:59], v[104:107], v[92:95]
    v_cvt_pk_bf16_f32 v124, v116, v117
    v_cvt_pk_bf16_f32 v125, v118, v119
    v_cvt_pk_bf16_f32 v126, v120, v121
    v_cvt_pk_bf16_f32 v127, v122, v123
    s_waitcnt lgkmcnt(10)
    v_mfma_f32_16x16x32_bf16 v[92:95], a[24:27], v[108:111], v[92:95]
    v_mfma_f32_16x16x32_bf16 v[88:91], v[124:127], a[92:95], v[88:91]
    v_mfma_f32_16x16x32_bf16 v[92:95], v[124:127], a[84:87], v[92:95]
    s_waitcnt lgkmcnt(9)
    v_mfma_f32_16x16x32_bf16 v[116:119], v[112:115], a[112:115], 0
    v_mfma_f32_16x16x32_bf16 v[120:123], v[112:115], a[116:119], 0
    s_waitcnt lgkmcnt(8)
    v_mfma_f32_16x16x32_bf16 v[64:67], a[28:31], v[24:27], v[64:67]
    v_mfma_f32_16x16x32_bf16 v[68:71], a[60:63], v[24:27], v[68:71]
    s_waitcnt lgkmcnt(7)
    v_mfma_f32_16x16x32_bf16 v[68:71], a[28:31], v[28:31], v[68:71]
    v_mfma_f32_16x16x32_bf16 v[72:75], a[60:63], v[28:31], v[72:75]
    s_waitcnt lgkmcnt(6)
    v_mfma_f32_16x16x32_bf16 v[72:75], a[28:31], v[32:35], v[72:75]
    v_mfma_f32_16x16x32_bf16 v[76:79], a[60:63], v[32:35], v[76:79]
    v_cvt_pk_bf16_f32 v124, v116, v117
    v_cvt_pk_bf16_f32 v125, v118, v119
    v_cvt_pk_bf16_f32 v126, v120, v121
    v_cvt_pk_bf16_f32 v127, v122, v123
    s_waitcnt lgkmcnt(5)
    v_mfma_f32_16x16x32_bf16 v[76:79], a[28:31], v[36:39], v[76:79]
    v_mfma_f32_16x16x32_bf16 v[80:83], a[60:63], v[36:39], v[80:83]
    v_mfma_f32_16x16x32_bf16 v[92:95], v[124:127], a[88:91], v[92:95]
    s_waitcnt lgkmcnt(4)
    v_mfma_f32_16x16x32_bf16 v[116:119], v[40:43], a[112:115], 0
    v_mfma_f32_16x16x32_bf16 v[120:123], v[40:43], a[116:119], 0
    s_waitcnt lgkmcnt(3)
    v_mfma_f32_16x16x32_bf16 v[80:83], a[28:31], v[44:47], v[80:83]
    v_mfma_f32_16x16x32_bf16 v[84:87], a[60:63], v[44:47], v[84:87]
    s_waitcnt lgkmcnt(2)
    v_mfma_f32_16x16x32_bf16 v[84:87], a[28:31], v[48:51], v[84:87]
    v_mfma_f32_16x16x32_bf16 v[88:91], a[60:63], v[48:51], v[88:91]
    s_waitcnt lgkmcnt(1)
    v_mfma_f32_16x16x32_bf16 v[88:91], a[28:31], v[52:55], v[88:91]
    v_mfma_f32_16x16x32_bf16 v[92:95], a[60:63], v[52:55], v[92:95]
    v_cvt_pk_bf16_f32 v124, v116, v117
    v_cvt_pk_bf16_f32 v125, v118, v119
    v_cvt_pk_bf16_f32 v126, v120, v121
    v_cvt_pk_bf16_f32 v127, v122, v123
    s_waitcnt lgkmcnt(0)
    v_mfma_f32_16x16x32_bf16 v[92:95], a[28:31], v[56:59], v[92:95]
    v_mfma_f32_16x16x32_bf16 v[92:95], v[124:127], a[92:95], v[92:95]
    v_cvt_pk_bf16_f32 v24, v64, v65
    v_cvt_pk_bf16_f32 v25, v66, v67
    v_cvt_pk_bf16_f32 v26, v68, v69
    v_cvt_pk_bf16_f32 v27, v70, v71
    s_nop 0
    v_permlane16_swap_b32 v24, v26
    v_permlane16_swap_b32 v25, v27
    buffer_store_dwordx4 v[24:27], v17, s[68:71], s86 offen offset:0 sc1
    v_cvt_pk_bf16_f32 v28, v72, v73
    v_cvt_pk_bf16_f32 v29, v74, v75
    v_cvt_pk_bf16_f32 v30, v76, v77
    v_cvt_pk_bf16_f32 v31, v78, v79
    s_nop 0
    v_permlane16_swap_b32 v28, v30
    v_permlane16_swap_b32 v29, v31
    buffer_store_dwordx4 v[28:31], v17, s[68:71], s86 offen offset:1024 sc1
    v_cvt_pk_bf16_f32 v32, v80, v81
    v_cvt_pk_bf16_f32 v33, v82, v83
    v_cvt_pk_bf16_f32 v34, v84, v85
    v_cvt_pk_bf16_f32 v35, v86, v87
    s_nop 0
    v_permlane16_swap_b32 v32, v34
    v_permlane16_swap_b32 v33, v35
    buffer_store_dwordx4 v[32:35], v17, s[68:71], s86 offen offset:2048 sc1
    v_cvt_pk_bf16_f32 v36, v88, v89
    v_cvt_pk_bf16_f32 v37, v90, v91
    v_cvt_pk_bf16_f32 v38, v92, v93
    v_cvt_pk_bf16_f32 v39, v94, v95
    s_nop 0
    v_permlane16_swap_b32 v36, v38
    v_permlane16_swap_b32 v37, v39
    buffer_store_dwordx4 v[36:39], v17, s[68:71], s86 offen offset:3072 sc1
    s_waitcnt vmcnt(0)
    v_mov_b32 v20, 1
    s_mov_b64 exec, 1
    ds_add_rtn_u32 v20, v0, v20 offset:64
    s_mov_b64 exec, -1
    s_waitcnt lgkmcnt(0)
    v_readfirstlane_b32 s79, v20
    s_nop 0
    s_cmp_lg_u32 s79, s88
    s_cbranch_scc1 L_ynl
    s_mov_b64 exec, 1
    buffer_store_dword v9, v10, s[68:71], s89 offen sc1
    s_mov_b64 exec, -1
L_ynl:
    s_endpgm
L_serv:
    s_setprio 3
    s_mov_b32 s60, s40
    s_mov_b32 s61, s41
    s_mov_b32 s62, 6291456
    s_mov_b32 s63, 0x20000
    v_bfe_u32 v12, v1, 2, 2
    v_mul_u32_u24 v12, 1344, v12
    v_lshrrev_b32 v13, 4, v1
    v_lshl_add_u32 v12, v13, 5, v12
    v_and_b32 v13, 3, v1
    v_lshl_add_u32 v12, v13, 3, v12
    v_add_u32 v12, 8704, v12
    s_mul_i32 s84, s2, 10240
    s_add_u32 s84, s84, 524288
    s_add_u32 s85, s84, 4096
    s_add_u32 s86, s84, 8192
    s_lshl_b32 s87, s2, 4
    s_add_u32 s87, s87, 16384
    v_lshlrev_b32 v13, 12, v1
    s_lshr_b32 s89, s2, 2
    s_lshl_b32 s89, s89, 7
    s_and_b32 s51, s2, 3
    s_lshl2_add_u32 s89, s51, s89
    s_add_u32 s89, s89, 393216
    v_lshlrev_b32 v14, 7, v1
    v_mov_b32 v23, 0x3f80
    v_add_u32 v22, 159744, v2
    v_and_b32 v124, 15, v1
    v_lshrrev_b32 v125, 4, v1
    v_lshlrev_b32 v125, 3, v125
    s_mov_b32 s50, 0x8001
    s_mov_b32 s51, 0x10001
    v_mov_b32 v126, 0x7c0
    v_lshlrev_b32 v126, v124, v126
    v_lshrrev_b32 v126, v125, v126
    v_bfe_u32 v24, v126, 0, 2
    v_mul_u32_u24 v24, s50, v24
    v_and_b32 v24, s51, v24
    v_mul_u32_u24 v24, v23, v24
    v_bfe_u32 v25, v126, 2, 2
    v_mul_u32_u24 v25, s50, v25
    v_and_b32 v25, s51, v25
    v_mul_u32_u24 v25, v23, v25
    v_bfe_u32 v26, v126, 4, 2
    v_mul_u32_u24 v26, s50, v26
    v_and_b32 v26, s51, v26
    v_mul_u32_u24 v26, v23, v26
    v_bfe_u32 v27, v126, 6, 2
    v_mul_u32_u24 v27, s50, v27
    v_and_b32 v27, s51, v27
    v_mul_u32_u24 v27, v23, v27
    ds_write_b128 v22, v[24:27] offset:0
    v_mov_b32 v126, 0x3800
    v_lshlrev_b32 v126, v124, v126
    v_lshrrev_b32 v126, v125, v126
    v_bfe_u32 v28, v126, 0, 2
    v_mul_u32_u24 v28, s50, v28
    v_and_b32 v28, s51, v28
    v_mul_u32_u24 v28, v23, v28
    v_bfe_u32 v29, v126, 2, 2
    v_mul_u32_u24 v29, s50, v29
    v_and_b32 v29, s51, v29
    v_mul_u32_u24 v29, v23, v29
    v_bfe_u32 v30, v126, 4, 2
    v_mul_u32_u24 v30, s50, v30
    v_and_b32 v30, s51, v30
    v_mul_u32_u24 v30, v23, v30
    v_bfe_u32 v31, v126, 6, 2
    v_mul_u32_u24 v31, s50, v31
    v_and_b32 v31, s51, v31
    v_mul_u32_u24 v31, v23, v31
    ds_write_b128 v22, v[28:31] offset:1024
    v_mov_b32 v126, 0x1ff0
    v_lshlrev_b32 v126, v124, v126
    v_lshrrev_b32 v126, v125, v126
    v_bfe_u32 v32, v126, 0, 2
    v_mul_u32_u24 v32, s50, v32
    v_and_b32 v32, s51, v32
    v_mul_u32_u24 v32, v23, v32
    v_bfe_u32 v33, v126, 2, 2
    v_mul_u32_u24 v33, s50, v33
    v_and_b32 v33, s51, v33
    v_mul_u32_u24 v33, v23, v33
    v_bfe_u32 v34, v126, 4, 2
    v_mul_u32_u24 v34, s50, v34
    v_and_b32 v34, s51, v34
    v_mul_u32_u24 v34, v23, v34
    v_bfe_u32 v35, v126, 6, 2
    v_mul_u32_u24 v35, s50, v35
    v_and_b32 v35, s51, v35
    v_mul_u32_u24 v35, v23, v35
    ds_write_b128 v22, v[32:35] offset:2048
    v_mov_b32 v126, 0xfe0
    v_lshlrev_b32 v126, v124, v126
    v_lshrrev_b32 v126, v125, v126
    v_bfe_u32 v36, v126, 0, 2
    v_mul_u32_u24 v36, s50, v36
    v_and_b32 v36, s51, v36
    v_mul_u32_u24 v36, v23, v36
    v_bfe_u32 v37, v126, 2, 2
    v_mul_u32_u24 v37, s50, v37
    v_and_b32 v37, s51, v37
    v_mul_u32_u24 v37, v23, v37
    v_bfe_u32 v38, v126, 4, 2
    v_mul_u32_u24 v38, s50, v38
    v_and_b32 v38, s51, v38
    v_mul_u32_u24 v38, v23, v38
    v_bfe_u32 v39, v126, 6, 2
    v_mul_u32_u24 v39, s50, v39
    v_and_b32 v39, s51, v39
    v_mul_u32_u24 v39, v23, v39
    ds_write_b128 v22, v[36:39] offset:3072
    s_waitcnt lgkmcnt(0)
    s_mul_i32 s10, s10, 0x9E3779B1
    s_add_u32 s10, s10, 0x7F4A7C15
    v_mov_b32 v9, s10
    ds_write_b32 v0, v9 offset:44
    s_mov_b32 s78, 0
    s_branch Lspinf_49
Lspin_47:
    s_sleep 1
Lspinf_49:
    ds_read_b32 v20, v0 offset:0
    s_add_u32 s78, s78, 1
    s_waitcnt lgkmcnt(0)
    v_readfirstlane_b32 s79, v20
    s_cmp_gt_u32 s78, 0x200000
    s_cbranch_scc1 Lspind_48
    s_cmp_lt_u32 s79, 4
    s_cbranch_scc1 Lspin_47
Lspind_48:
    ds_read_b64_tr_b16 v[24:25], v12 offset:0
    ds_read_b64_tr_b16 v[26:27], v12 offset:14976
    ds_read_b64_tr_b16 v[28:29], v12 offset:128
    ds_read_b64_tr_b16 v[30:31], v12 offset:15104
    ds_read_b64_tr_b16 v[32:33], v12 offset:256
    ds_read_b64_tr_b16 v[34:35], v12 offset:15232
    ds_read_b64_tr_b16 v[36:37], v12 offset:384
    ds_read_b64_tr_b16 v[38:39], v12 offset:15360
    s_waitcnt lgkmcnt(6)
    buffer_store_dwordx4 v[24:27], v2, s[68:71], s84 offen offset:0 sc1
    ds_read_b64_tr_b16 v[40:41], v12 offset:512
    ds_read_b64_tr_b16 v[42:43], v12 offset:15488
    s_waitcnt lgkmcnt(6)
    buffer_store_dwordx4 v[28:31], v2, s[68:71], s84 offen offset:1024 sc1
    ds_read_b64_tr_b16 v[44:45], v12 offset:640
    ds_read_b64_tr_b16 v[46:47], v12 offset:15616
    s_waitcnt lgkmcnt(6)
    buffer_store_dwordx4 v[32:35], v2, s[68:71], s84 offen offset:2048 sc1
    ds_read_b64_tr_b16 v[48:49], v12 offset:768
    ds_read_b64_tr_b16 v[50:51], v12 offset:15744
    s_waitcnt lgkmcnt(6)
    buffer_store_dwordx4 v[36:39], v2, s[68:71], s84 offen offset:3072 sc1
    ds_read_b64_tr_b16 v[52:53], v12 offset:896
    ds_read_b64_tr_b16 v[54:55], v12 offset:15872
    s_waitcnt lgkmcnt(6)
    buffer_store_dwordx4 v[40:43], v2, s[68:71], s85 offen offset:0 sc1
    ds_read_b64_tr_b16 v[56:57], v12 offset:1024
    ds_read_b64_tr_b16 v[58:59], v12 offset:16000
    s_waitcnt lgkmcnt(6)
    buffer_store_dwordx4 v[44:47], v2, s[68:71], s85 offen offset:1024 sc1
    ds_read_b64_tr_b16 v[60:61], v12 offset:1152
    ds_read_b64_tr_b16 v[62:63], v12 offset:16128
    s_waitcnt lgkmcnt(6)
    buffer_store_dwordx4 v[48:51], v2, s[68:71], s85 offen offset:2048 sc1
    ds_read_b64_tr_b16 v[64:65], v12 offset:1280
    ds_read_b64_tr_b16 v[66:67], v12 offset:16256
    s_waitcnt lgkmcnt(6)
    buffer_store_dwordx4 v[52:55], v2, s[68:71], s85 offen offset:3072 sc1
    s_waitcnt lgkmcnt(4)
    buffer_store_dwordx4 v[56:59], v2, s[68:71], s86 offen offset:0 sc1
    s_waitcnt lgkmcnt(2)
    buffer_store_dwordx4 v[60:63], v2, s[68:71], s86 offen offset:1024 sc1
    s_waitcnt lgkmcnt(0)
    s_mov_b64 exec, 3
    buffer_store_dwordx4 v[64:67], v13, s[68:71], s87 offen sc1
    s_mov_b64 exec, -1
    v_mov_b32 v20, 1
    s_mov_b64 exec, 1
    ds_add_u32 v0, v20 offset:16
    s_mov_b64 exec, -1
    s_mul_i32 s50, s8, 80
    s_lshr_b32 s50, s50, 6
    s_mul_i32 s92, s50, 3072
    s_add_u32 s92, s92, 327680
    v_min_u32 v15, 47, v1
    v_lshlrev_b32 v15, 7, v15
    v_min_u32 v16, 29, v1
    v_lshlrev_b32 v16, 7, v16
    s_mul_i32 s93, s8, 3840
    s_add_u32 s93, s93, 360448
    s_waitcnt vmcnt(0)
    s_mov_b64 exec, 1
    buffer_store_dword v9, v10, s[68:71], s89 offen sc1
    s_mov_b64 exec, -1
    v_mov_b32 v20, 1
    s_mov_b64 exec, 1
    ds_add_u32 v0, v20 offset:16
    s_mov_b64 exec, -1
    s_cmp_lt_u32 s5, 30
    s_cbranch_scc1 L_s1
    v_lshrrev_b32 v17, 3, v1
    v_lshlrev_b32 v17, 12, v17
    v_and_b32 v18, 7, v1
    v_lshl_add_u32 v17, v18, 7, v17
    s_lshl_b32 s88, s97, 10
    s_and_b32 s51, s5, 1
    s_lshl_b32 s51, s51, 15
    s_add_u32 s88, s88, s51
    s_and_b32 s51, s4, 1
    s_lshl_b32 s51, s51, 16
    s_add_u32 s88, s88, s51
    s_waitcnt vmcnt(0)
    v_mov_b32 v20, 1
    s_mov_b64 exec, 1
    ds_add_u32 v0, v20 offset:4
    s_mov_b64 exec, -1
    s_branch L_s2
L_s1:
    v_lshrrev_b32 v20, 4, v1
    v_lshlrev_b32 v20, 10, v20
    v_and_b32 v21, 3, v1
    v_lshl_add_u32 v20, v21, 4, v20
    v_and_b32 v21, 12, v1
    v_add_u32 v22, 0, v21
    v_bfe_u32 v22, s74, v22, 4
    v_lshl_add_u32 v4, v22, 6, v20
    v_add_u32 v22, 16, v21
    v_bfe_u32 v22, s74, v22, 4
    v_lshl_add_u32 v5, v22, 6, v20
    v_add_u32 v22, 0, v21
    v_bfe_u32 v22, s75, v22, 4
    v_lshl_add_u32 v6, v22, 6, v20
    v_add_u32 v22, 16, v21
    v_bfe_u32 v22, s75, v22, 4
    v_lshl_add_u32 v7, v22, 6, v20
    s_mov_b32 s84, 16384
    s_mov_b32 s85, 20480
    s_mov_b32 s78, 0
    s_branch Lspinf_52
Lspin_50:
    s_sleep 2
Lspinf_52:
    ds_read_b32 v20, v0 offset:20
    s_add_u32 s78, s78, 1
    s_waitcnt lgkmcnt(0)
    v_readfirstlane_b32 s79, v20
    s_cmp_gt_u32 s78, 0x200000
    s_cbranch_scc1 Lspind_51
    s_cmp_lt_u32 s79, 1
    s_cbranch_scc1 Lspin_50
Lspind_51:
    s_mov_b32 s50, 393216
    s_mov_b32 s78, 0
    s_branch Lpollf_55
Lpoll_53:
    s_sleep 4
Lpollf_55:
    buffer_load_dwordx4 v[20:23], v14, s[68:71], s50 offen sc1
    s_add_u32 s78, s78, 1
    s_waitcnt vmcnt(0)
    v_xor_b32 v20, s10, v20
    v_xor_b32 v21, s10, v21
    v_xor_b32 v22, s10, v22
    v_xor_b32 v23, s10, v23
    v_or3_b32 v20, v20, v21, v22
    v_or_b32 v20, v20, v23
    v_cmp_ne_u32 vcc, 0, v20
    s_cmp_gt_u32 s78, 0x40000
    s_cbranch_scc1 Lpolld_54
    s_cbranch_vccz Lpolld_54
    s_mov_b64 exec, vcc
    s_branch Lpoll_53
Lpolld_54:
    s_mov_b64 exec, -1
    v_mov_b32 v20, 1
    s_mov_b64 exec, 1
    ds_add_u32 v0, v20 offset:4
    s_mov_b64 exec, -1
    buffer_load_dwordx4 v[24:27], v4, s[68:71], s84 offen sc1
    buffer_load_dwordx4 v[40:43], v4, s[68:71], s85 offen sc1
    buffer_load_dwordx4 v[28:31], v5, s[68:71], s84 offen sc1
    buffer_load_dwordx4 v[44:47], v5, s[68:71], s85 offen sc1
    buffer_load_dwordx4 v[32:35], v6, s[68:71], s84 offen sc1
    buffer_load_dwordx4 v[48:51], v6, s[68:71], s85 offen sc1
    buffer_load_dwordx4 v[36:39], v7, s[68:71], s84 offen sc1
    buffer_load_dwordx4 v[52:55], v7, s[68:71], s85 offen sc1
    s_setprio 0
    s_waitcnt vmcnt(0)
    v_lshlrev_b32 v56, 16, v24
    v_and_b32 v57, 0xffff0000, v24
    v_lshlrev_b32 v58, 16, v25
    v_and_b32 v59, 0xffff0000, v25
    v_lshlrev_b32 v60, 16, v26
    v_and_b32 v61, 0xffff0000, v26
    v_lshlrev_b32 v62, 16, v27
    v_and_b32 v63, 0xffff0000, v27
    v_lshlrev_b32 v64, 16, v28
    v_and_b32 v65, 0xffff0000, v28
    v_lshlrev_b32 v66, 16, v29
    v_and_b32 v67, 0xffff0000, v29
    v_lshlrev_b32 v68, 16, v30
    v_and_b32 v69, 0xffff0000, v30
    v_lshlrev_b32 v70, 16, v31
    v_and_b32 v71, 0xffff0000, v31
    v_lshlrev_b32 v72, 16, v32
    v_and_b32 v73, 0xffff0000, v32
    v_lshlrev_b32 v74, 16, v33
    v_and_b32 v75, 0xffff0000, v33
    v_lshlrev_b32 v76, 16, v34
    v_and_b32 v77, 0xffff0000, v34
    v_lshlrev_b32 v78, 16, v35
    v_and_b32 v79, 0xffff0000, v35
    v_lshlrev_b32 v80, 16, v36
    v_and_b32 v81, 0xffff0000, v36
    v_lshlrev_b32 v82, 16, v37
    v_and_b32 v83, 0xffff0000, v37
    v_lshlrev_b32 v84, 16, v38
    v_and_b32 v85, 0xffff0000, v38
    v_lshlrev_b32 v86, 16, v39
    v_and_b32 v87, 0xffff0000, v39
    v_lshlrev_b32 v88, 16, v40
    v_and_b32 v89, 0xffff0000, v40
    v_lshlrev_b32 v90, 16, v41
    v_and_b32 v91, 0xffff0000, v41
    v_lshlrev_b32 v92, 16, v42
    v_and_b32 v93, 0xffff0000, v42
    v_lshlrev_b32 v94, 16, v43
    v_and_b32 v95, 0xffff0000, v43
    v_lshlrev_b32 v96, 16, v44
    v_and_b32 v97, 0xffff0000, v44
    v_lshlrev_b32 v98, 16, v45
    v_and_b32 v99, 0xffff0000, v45
    v_lshlrev_b32 v100, 16, v46
    v_and_b32 v101, 0xffff0000, v46
    v_lshlrev_b32 v102, 16, v47
    v_and_b32 v103, 0xffff0000, v47
    v_lshlrev_b32 v104, 16, v48
    v_and_b32 v105, 0xffff0000, v48
    v_lshlrev_b32 v106, 16, v49
    v_and_b32 v107, 0xffff0000, v49
    v_lshlrev_b32 v108, 16, v50
    v_and_b32 v109, 0xffff0000, v50
    v_lshlrev_b32 v110, 16, v51
    v_and_b32 v111, 0xffff0000, v51
    v_lshlrev_b32 v112, 16, v52
    v_and_b32 v113, 0xffff0000, v52
    v_lshlrev_b32 v114, 16, v53
    v_and_b32 v115, 0xffff0000, v53
    v_lshlrev_b32 v116, 16, v54
    v_and_b32 v117, 0xffff0000, v54
    v_lshlrev_b32 v118, 16, v55
    v_and_b32 v119, 0xffff0000, v55
    s_mov_b32 s78, 0
    s_branch Lspinf_58
Lspin_56:
    s_sleep 2
Lspinf_58:
    ds_read_b32 v22, v0 offset:48
    s_add_u32 s78, s78, 1
    s_waitcnt lgkmcnt(0)
    v_readfirstlane_b32 s79, v22
    s_cmp_gt_u32 s78, 0x200000
    s_cbranch_scc1 Lspind_57
    s_cmp_lt_u32 s79, 4
    s_cbranch_scc1 Lspin_56
Lspind_57:
    ds_read_b128 v[24:27], v4 offset:10880
    ds_read_b128 v[28:31], v4 offset:25856
    ds_read_b128 v[32:35], v4 offset:40832
    s_waitcnt lgkmcnt(2)
    v_lshlrev_b32 v40, 16, v24
    v_and_b32 v41, 0xffff0000, v24
    v_lshlrev_b32 v42, 16, v25
    v_and_b32 v43, 0xffff0000, v25
    v_lshlrev_b32 v44, 16, v26
    v_and_b32 v45, 0xffff0000, v26
    v_lshlrev_b32 v46, 16, v27
    v_and_b32 v47, 0xffff0000, v27
    v_fma_f32 v40, v40, v56, v88
    v_fma_f32 v41, v41, v57, v89
    v_fma_f32 v42, v42, v58, v90
    v_fma_f32 v43, v43, v59, v91
    v_fma_f32 v44, v44, v60, v92
    v_fma_f32 v45, v45, v61, v93
    v_fma_f32 v46, v46, v62, v94
    v_fma_f32 v47, v47, v63, v95
    v_cvt_pk_bf16_f32 v48, v40, v41
    v_cvt_pk_bf16_f32 v49, v42, v43
    v_cvt_pk_bf16_f32 v50, v44, v45
    v_cvt_pk_bf16_f32 v51, v46, v47
    ds_write_b128 v4, v[48:51] offset:10880
    s_waitcnt lgkmcnt(2)
    v_lshlrev_b32 v40, 16, v28
    v_and_b32 v41, 0xffff0000, v28
    v_lshlrev_b32 v42, 16, v29
    v_and_b32 v43, 0xffff0000, v29
    v_lshlrev_b32 v44, 16, v30
    v_and_b32 v45, 0xffff0000, v30
    v_lshlrev_b32 v46, 16, v31
    v_and_b32 v47, 0xffff0000, v31
    v_fma_f32 v40, v40, v56, v88
    v_fma_f32 v41, v41, v57, v89
    v_fma_f32 v42, v42, v58, v90
    v_fma_f32 v43, v43, v59, v91
    v_fma_f32 v44, v44, v60, v92
    v_fma_f32 v45, v45, v61, v93
    v_fma_f32 v46, v46, v62, v94
    v_fma_f32 v47, v47, v63, v95
    v_cvt_pk_bf16_f32 v52, v40, v41
    v_cvt_pk_bf16_f32 v53, v42, v43
    v_cvt_pk_bf16_f32 v54, v44, v45
    v_cvt_pk_bf16_f32 v55, v46, v47
    ds_write_b128 v4, v[52:55] offset:25856
    s_waitcnt lgkmcnt(2)
    v_lshlrev_b32 v40, 16, v32
    v_and_b32 v41, 0xffff0000, v32
    v_lshlrev_b32 v42, 16, v33
    v_and_b32 v43, 0xffff0000, v33
    v_lshlrev_b32 v44, 16, v34
    v_and_b32 v45, 0xffff0000, v34
    v_lshlrev_b32 v46, 16, v35
    v_and_b32 v47, 0xffff0000, v35
    v_fma_f32 v40, v40, v56, v88
    v_fma_f32 v41, v41, v57, v89
    v_fma_f32 v42, v42, v58, v90
    v_fma_f32 v43, v43, v59, v91
    v_fma_f32 v44, v44, v60, v92
    v_fma_f32 v45, v45, v61, v93
    v_fma_f32 v46, v46, v62, v94
    v_fma_f32 v47, v47, v63, v95
    v_cvt_pk_bf16_f32 v48, v40, v41
    v_cvt_pk_bf16_f32 v49, v42, v43
    v_cvt_pk_bf16_f32 v50, v44, v45
    v_cvt_pk_bf16_f32 v51, v46, v47
    ds_write_b128 v4, v[48:51] offset:40832
    s_mov_b32 s78, 0
    s_branch Lspinf_61
Lspin_59:
    s_sleep 2
Lspinf_61:
    ds_read_b32 v22, v0 offset:52
    s_add_u32 s78, s78, 1
    s_waitcnt lgkmcnt(0)
    v_readfirstlane_b32 s79, v22
    s_cmp_gt_u32 s78, 0x200000
    s_cbranch_scc1 Lspind_60
    s_cmp_lt_u32 s79, 4
    s_cbranch_scc1 Lspin_59
Lspind_60:
    ds_read_b128 v[24:27], v5 offset:10880
    ds_read_b128 v[28:31], v5 offset:25856
    ds_read_b128 v[32:35], v5 offset:40832
    s_waitcnt lgkmcnt(2)
    v_lshlrev_b32 v40, 16, v24
    v_and_b32 v41, 0xffff0000, v24
    v_lshlrev_b32 v42, 16, v25
    v_and_b32 v43, 0xffff0000, v25
    v_lshlrev_b32 v44, 16, v26
    v_and_b32 v45, 0xffff0000, v26
    v_lshlrev_b32 v46, 16, v27
    v_and_b32 v47, 0xffff0000, v27
    v_fma_f32 v40, v40, v64, v96
    v_fma_f32 v41, v41, v65, v97
    v_fma_f32 v42, v42, v66, v98
    v_fma_f32 v43, v43, v67, v99
    v_fma_f32 v44, v44, v68, v100
    v_fma_f32 v45, v45, v69, v101
    v_fma_f32 v46, v46, v70, v102
    v_fma_f32 v47, v47, v71, v103
    v_cvt_pk_bf16_f32 v48, v40, v41
    v_cvt_pk_bf16_f32 v49, v42, v43
    v_cvt_pk_bf16_f32 v50, v44, v45
    v_cvt_pk_bf16_f32 v51, v46, v47
    ds_write_b128 v5, v[48:51] offset:10880
    s_waitcnt lgkmcnt(2)
    v_lshlrev_b32 v40, 16, v28
    v_and_b32 v41, 0xffff0000, v28
    v_lshlrev_b32 v42, 16, v29
    v_and_b32 v43, 0xffff0000, v29
    v_lshlrev_b32 v44, 16, v30
    v_and_b32 v45, 0xffff0000, v30
    v_lshlrev_b32 v46, 16, v31
    v_and_b32 v47, 0xffff0000, v31
    v_fma_f32 v40, v40, v64, v96
    v_fma_f32 v41, v41, v65, v97
    v_fma_f32 v42, v42, v66, v98
    v_fma_f32 v43, v43, v67, v99
    v_fma_f32 v44, v44, v68, v100
    v_fma_f32 v45, v45, v69, v101
    v_fma_f32 v46, v46, v70, v102
    v_fma_f32 v47, v47, v71, v103
    v_cvt_pk_bf16_f32 v52, v40, v41
    v_cvt_pk_bf16_f32 v53, v42, v43
    v_cvt_pk_bf16_f32 v54, v44, v45
    v_cvt_pk_bf16_f32 v55, v46, v47
    ds_write_b128 v5, v[52:55] offset:25856
    s_waitcnt lgkmcnt(2)
    v_lshlrev_b32 v40, 16, v32
    v_and_b32 v41, 0xffff0000, v32
    v_lshlrev_b32 v42, 16, v33
    v_and_b32 v43, 0xffff0000, v33
    v_lshlrev_b32 v44, 16, v34
    v_and_b32 v45, 0xffff0000, v34
    v_lshlrev_b32 v46, 16, v35
    v_and_b32 v47, 0xffff0000, v35
    v_fma_f32 v40, v40, v64, v96
    v_fma_f32 v41, v41, v65, v97
    v_fma_f32 v42, v42, v66, v98
    v_fma_f32 v43, v43, v67, v99
    v_fma_f32 v44, v44, v68, v100
    v_fma_f32 v45, v45, v69, v101
    v_fma_f32 v46, v46, v70, v102
    v_fma_f32 v47, v47, v71, v103
    v_cvt_pk_bf16_f32 v48, v40, v41
    v_cvt_pk_bf16_f32 v49, v42, v43
    v_cvt_pk_bf16_f32 v50, v44, v45
    v_cvt_pk_bf16_f32 v51, v46, v47
    ds_write_b128 v5, v[48:51] offset:40832
    s_mov_b32 s78, 0
    s_branch Lspinf_64
Lspin_62:
    s_sleep 2
Lspinf_64:
    ds_read_b32 v22, v0 offset:56
    s_add_u32 s78, s78, 1
    s_waitcnt lgkmcnt(0)
    v_readfirstlane_b32 s79, v22
    s_cmp_gt_u32 s78, 0x200000
    s_cbranch_scc1 Lspind_63
    s_cmp_lt_u32 s79, 4
    s_cbranch_scc1 Lspin_62
Lspind_63:
    ds_read_b128 v[24:27], v6 offset:10880
    ds_read_b128 v[28:31], v6 offset:25856
    ds_read_b128 v[32:35], v6 offset:40832
    s_waitcnt lgkmcnt(2)
    v_lshlrev_b32 v40, 16, v24
    v_and_b32 v41, 0xffff0000, v24
    v_lshlrev_b32 v42, 16, v25
    v_and_b32 v43, 0xffff0000, v25
    v_lshlrev_b32 v44, 16, v26
    v_and_b32 v45, 0xffff0000, v26
    v_lshlrev_b32 v46, 16, v27
    v_and_b32 v47, 0xffff0000, v27
    v_fma_f32 v40, v40, v72, v104
    v_fma_f32 v41, v41, v73, v105
    v_fma_f32 v42, v42, v74, v106
    v_fma_f32 v43, v43, v75, v107
    v_fma_f32 v44, v44, v76, v108
    v_fma_f32 v45, v45, v77, v109
    v_fma_f32 v46, v46, v78, v110
    v_fma_f32 v47, v47, v79, v111
    v_cvt_pk_bf16_f32 v48, v40, v41
    v_cvt_pk_bf16_f32 v49, v42, v43
    v_cvt_pk_bf16_f32 v50, v44, v45
    v_cvt_pk_bf16_f32 v51, v46, v47
    ds_write_b128 v6, v[48:51] offset:10880
    s_waitcnt lgkmcnt(2)
    v_lshlrev_b32 v40, 16, v28
    v_and_b32 v41, 0xffff0000, v28
    v_lshlrev_b32 v42, 16, v29
    v_and_b32 v43, 0xffff0000, v29
    v_lshlrev_b32 v44, 16, v30
    v_and_b32 v45, 0xffff0000, v30
    v_lshlrev_b32 v46, 16, v31
    v_and_b32 v47, 0xffff0000, v31
    v_fma_f32 v40, v40, v72, v104
    v_fma_f32 v41, v41, v73, v105
    v_fma_f32 v42, v42, v74, v106
    v_fma_f32 v43, v43, v75, v107
    v_fma_f32 v44, v44, v76, v108
    v_fma_f32 v45, v45, v77, v109
    v_fma_f32 v46, v46, v78, v110
    v_fma_f32 v47, v47, v79, v111
    v_cvt_pk_bf16_f32 v52, v40, v41
    v_cvt_pk_bf16_f32 v53, v42, v43
    v_cvt_pk_bf16_f32 v54, v44, v45
    v_cvt_pk_bf16_f32 v55, v46, v47
    ds_write_b128 v6, v[52:55] offset:25856
    s_waitcnt lgkmcnt(2)
    v_lshlrev_b32 v40, 16, v32
    v_and_b32 v41, 0xffff0000, v32
    v_lshlrev_b32 v42, 16, v33
    v_and_b32 v43, 0xffff0000, v33
    v_lshlrev_b32 v44, 16, v34
    v_and_b32 v45, 0xffff0000, v34
    v_lshlrev_b32 v46, 16, v35
    v_and_b32 v47, 0xffff0000, v35
    v_fma_f32 v40, v40, v72, v104
    v_fma_f32 v41, v41, v73, v105
    v_fma_f32 v42, v42, v74, v106
    v_fma_f32 v43, v43, v75, v107
    v_fma_f32 v44, v44, v76, v108
    v_fma_f32 v45, v45, v77, v109
    v_fma_f32 v46, v46, v78, v110
    v_fma_f32 v47, v47, v79, v111
    v_cvt_pk_bf16_f32 v48, v40, v41
    v_cvt_pk_bf16_f32 v49, v42, v43
    v_cvt_pk_bf16_f32 v50, v44, v45
    v_cvt_pk_bf16_f32 v51, v46, v47
    ds_write_b128 v6, v[48:51] offset:40832
    s_mov_b32 s78, 0
    s_branch Lspinf_67
Lspin_65:
    s_sleep 1
Lspinf_67:
    ds_read_b32 v22, v0 offset:60
    s_add_u32 s78, s78, 1
    s_waitcnt lgkmcnt(0)
    v_readfirstlane_b32 s79, v22
    s_cmp_gt_u32 s78, 0x200000
    s_cbranch_scc1 Lspind_66
    s_cmp_lt_u32 s79, 4
    s_cbranch_scc1 Lspin_65
Lspind_66:
    ds_read_b128 v[24:27], v7 offset:10880
    ds_read_b128 v[28:31], v7 offset:25856
    ds_read_b128 v[32:35], v7 offset:40832
    s_waitcnt lgkmcnt(2)
    v_lshlrev_b32 v40, 16, v24
    v_and_b32 v41, 0xffff0000, v24
    v_lshlrev_b32 v42, 16, v25
    v_and_b32 v43, 0xffff0000, v25
    v_lshlrev_b32 v44, 16, v26
    v_and_b32 v45, 0xffff0000, v26
    v_lshlrev_b32 v46, 16, v27
    v_and_b32 v47, 0xffff0000, v27
    v_fma_f32 v40, v40, v80, v112
    v_fma_f32 v41, v41, v81, v113
    v_fma_f32 v42, v42, v82, v114
    v_fma_f32 v43, v43, v83, v115
    v_fma_f32 v44, v44, v84, v116
    v_fma_f32 v45, v45, v85, v117
    v_fma_f32 v46, v46, v86, v118
    v_fma_f32 v47, v47, v87, v119
    v_cvt_pk_bf16_f32 v48, v40, v41
    v_cvt_pk_bf16_f32 v49, v42, v43
    v_cvt_pk_bf16_f32 v50, v44, v45
    v_cvt_pk_bf16_f32 v51, v46, v47
    ds_write_b128 v7, v[48:51] offset:10880
    s_waitcnt lgkmcnt(2)
    v_lshlrev_b32 v40, 16, v28
    v_and_b32 v41, 0xffff0000, v28
    v_lshlrev_b32 v42, 16, v29
    v_and_b32 v43, 0xffff0000, v29
    v_lshlrev_b32 v44, 16, v30
    v_and_b32 v45, 0xffff0000, v30
    v_lshlrev_b32 v46, 16, v31
    v_and_b32 v47, 0xffff0000, v31
    v_fma_f32 v40, v40, v80, v112
    v_fma_f32 v41, v41, v81, v113
    v_fma_f32 v42, v42, v82, v114
    v_fma_f32 v43, v43, v83, v115
    v_fma_f32 v44, v44, v84, v116
    v_fma_f32 v45, v45, v85, v117
    v_fma_f32 v46, v46, v86, v118
    v_fma_f32 v47, v47, v87, v119
    v_cvt_pk_bf16_f32 v52, v40, v41
    v_cvt_pk_bf16_f32 v53, v42, v43
    v_cvt_pk_bf16_f32 v54, v44, v45
    v_cvt_pk_bf16_f32 v55, v46, v47
    ds_write_b128 v7, v[52:55] offset:25856
    s_waitcnt lgkmcnt(2)
    v_lshlrev_b32 v40, 16, v32
    v_and_b32 v41, 0xffff0000, v32
    v_lshlrev_b32 v42, 16, v33
    v_and_b32 v43, 0xffff0000, v33
    v_lshlrev_b32 v44, 16, v34
    v_and_b32 v45, 0xffff0000, v34
    v_lshlrev_b32 v46, 16, v35
    v_and_b32 v47, 0xffff0000, v35
    v_fma_f32 v40, v40, v80, v112
    v_fma_f32 v41, v41, v81, v113
    v_fma_f32 v42, v42, v82, v114
    v_fma_f32 v43, v43, v83, v115
    v_fma_f32 v44, v44, v84, v116
    v_fma_f32 v45, v45, v85, v117
    v_fma_f32 v46, v46, v86, v118
    v_fma_f32 v47, v47, v87, v119
    v_cvt_pk_bf16_f32 v48, v40, v41
    v_cvt_pk_bf16_f32 v49, v42, v43
    v_cvt_pk_bf16_f32 v50, v44, v45
    v_cvt_pk_bf16_f32 v51, v46, v47
    ds_write_b128 v7, v[48:51] offset:40832
    v_mov_b32 v20, 1
    s_mov_b64 exec, 1
    ds_add_u32 v0, v20 offset:68
    s_mov_b64 exec, -1
    s_setprio 3
L_s2:
    s_mov_b32 s78, 0
    s_branch Lspinf_70
Lspin_68:
    s_sleep 4
Lspinf_70:
    ds_read_b32 v20, v0 offset:28
    s_add_u32 s78, s78, 1
    s_waitcnt lgkmcnt(0)
    v_readfirstlane_b32 s79, v20
    s_cmp_gt_u32 s78, 0x200000
    s_cbranch_scc1 Lspind_69
    s_cmp_lt_u32 s79, 1
    s_cbranch_scc1 Lspin_68
Lspind_69:
    s_mov_b32 s78, 0
    s_branch Lpollf_73
Lpoll_71:
    s_sleep 8
Lpollf_73:
    buffer_load_dword v20, v15, s[68:71], s92 offen sc1
    s_add_u32 s78, s78, 1
    s_waitcnt vmcnt(0)
    v_cmp_ne_u32 vcc, s10, v20
    s_cmp_gt_u32 s78, 0x40000
    s_cbranch_scc1 Lpolld_72
    s_cbranch_vccz Lpolld_72
    s_mov_b64 exec, vcc
    s_branch Lpoll_71
Lpolld_72:
    s_mov_b64 exec, -1
    v_mov_b32 v20, 1
    s_mov_b64 exec, 1
    ds_add_u32 v0, v20 offset:32
    s_mov_b64 exec, -1
    s_mov_b32 s78, 0
    s_branch Lspinf_76
Lspin_74:
    s_sleep 4
Lspinf_76:
    ds_read_b32 v20, v0 offset:36
    s_add_u32 s78, s78, 1
    s_waitcnt lgkmcnt(0)
    v_readfirstlane_b32 s79, v20
    s_cmp_gt_u32 s78, 0x200000
    s_cbranch_scc1 Lspind_75
    s_cmp_lt_u32 s79, 1
    s_cbranch_scc1 Lspin_74
Lspind_75:
    s_mov_b32 s78, 0
    s_branch Lpollf_79
Lpoll_77:
    s_sleep 8
Lpollf_79:
    buffer_load_dword v20, v16, s[68:71], s93 offen sc1
    s_add_u32 s78, s78, 1
    s_waitcnt vmcnt(0)
    v_cmp_ne_u32 vcc, s10, v20
    s_cmp_gt_u32 s78, 0x40000
    s_cbranch_scc1 Lpolld_78
    s_cbranch_vccz Lpolld_78
    s_mov_b64 exec, vcc
    s_branch Lpoll_77
Lpolld_78:
    s_mov_b64 exec, -1
    v_mov_b32 v20, 1
    s_mov_b64 exec, 1
    ds_add_u32 v0, v20 offset:40
    s_mov_b64 exec, -1
    s_endpgm
L_end:
L_last:
    s_endpgm
.section .rodata,"a"
.p2align 6
.amdhsa_kernel parallel_sum__ssm_conv_s4__mixer_token_mlp__prompt_kernel
  .amdhsa_next_free_vgpr 256
  .amdhsa_next_free_sgpr 102
  .amdhsa_accum_offset 128
  .amdhsa_group_segment_fixed_size 0
  .amdhsa_kernarg_size 136
  .amdhsa_user_sgpr_count 2
  .amdhsa_user_sgpr_kernarg_segment_ptr 1
  .amdhsa_system_sgpr_workgroup_id_x 1
.end_amdhsa_kernel
```
